```python
import torch

def _softmax(x, axis=-1):
    return torch.softmax(x, dim=axis)
def _gelu(x):
    return torch.nn.functional.gelu(x, approximate="tanh")
def _silu(x):
    return torch.nn.functional.silu(x)
def _sigmoid(x):
    return torch.sigmoid(x)
def _layernorm(x, axis=-1, eps=1e-5):
    m = x.mean(dim=axis, keepdim=True)
    v = x.var(dim=axis, keepdim=True, unbiased=False)
    return (x - m) / torch.sqrt(v + eps)
def _scatter_add(tgt, idx, src, axis=0):
    return tgt.clone().index_add_(axis, idx, src)
def _segment_sum(src, seg, n):
    out = torch.zeros((n,) + src.shape[1:], dtype=src.dtype)
    return out.index_add_(0, seg, src)
def _pad(x, pw):
    flat = tuple(v for pair in reversed(pw) for v in pair)
    return torch.nn.functional.pad(x, flat)

kernel_name = 'interleave_layers__gqa_block_cached__compressed_kv_cla__decode'

def setup_inputs():

    _w = (lambda a: (lambda t: t.to(torch.bfloat16) if t.is_floating_point() else t)(torch.as_tensor(a)))
    def _A_setup():
        B, Sq, D = 1, 1, 640
        Hq, Hkv, Sk, Dh = 32, 32, 4096, 192
        assert Hq % Hkv == 0, (Hq, Hkv)
        return {
            "x": _w((lambda *s: torch.randn(*s, dtype=torch.bfloat16) * 0.05)(B, Sq, D)),
            "k_cache": _w((lambda *s: torch.randn(*s, dtype=torch.bfloat16) * 0.8)(B, Hkv, Sk, Dh)),
            "v_cache": _w((lambda *s: torch.randn(*s, dtype=torch.bfloat16) * 0.8)(B, Hkv, Sk, Dh)),
            "wq": _w((lambda *s: torch.randn(*s, dtype=torch.bfloat16) * 0.8)(D, Hq * Dh) * (D ** -0.5)),
            "wo": _w((lambda *s: torch.randn(*s, dtype=torch.bfloat16) * 0.8)(Hq * Dh, D) * ((Hq * Dh) ** -0.5)),
        }
    _A_in = _A_setup()

    def _B_setup():
        B, H, Sq, Sk, D, M = 1, 32, 1, 4096, 192, 640
        Dc = 4 * D
        return {
            "x": _w((lambda *s: torch.randn(*s, dtype=torch.bfloat16) * 0.05)(B, Sq, M)),
            "c_kv": _w((lambda *s: torch.randn(*s, dtype=torch.bfloat16) * 0.4)(B, Sk, Dc)),
            "w_q": _w((lambda *s: torch.randn(*s, dtype=torch.bfloat16) * 3.2)(M, H, D) * (M ** -0.5)),
            "w_uk": _w((lambda *s: torch.randn(*s, dtype=torch.bfloat16) * 3.2)(Dc, H, D) * (Dc ** -0.5)),
            "w_uv": _w((lambda *s: torch.randn(*s, dtype=torch.bfloat16) * 0.4)(Dc, H, D) * (Dc ** -0.5)),
            "w_o": _w((lambda *s: torch.randn(*s, dtype=torch.bfloat16) * 0.4)(H, D, M) * ((H * D) ** -0.5)),
        }
    _B_in = _B_setup()

    return {
        "A_x": _A_in["x"],
        "A_k_cache": _A_in["k_cache"],
        "A_v_cache": _A_in["v_cache"],
        "A_wq": _A_in["wq"],
        "A_wo": _A_in["wo"],
        "B_x": _B_in["x"],
        "B_c_kv": _B_in["c_kv"],
        "B_w_q": _B_in["w_q"],
        "B_w_uk": _B_in["w_uk"],
        "B_w_uv": _B_in["w_uv"],
        "B_w_o": _B_in["w_o"],
    }

def reference(A_x, A_k_cache, A_v_cache, A_wq, A_wo, B_x, B_c_kv, B_w_q, B_w_uk, B_w_uv, B_w_o):
    def _A_ref(x, k_cache, v_cache, wq, wo):
        B, Sq, D = x.shape
        Hq, Dh = 32, 192
        Hkv = k_cache.shape[1]
        rep = Hq // Hkv
        q = (lambda x, *d: x.permute(*d))((x @ wq).reshape(B, Sq, Hq, Dh), 0, 2, 1, 3)
        k = (lambda x, n, axis: torch.repeat_interleave(x, n, dim=axis))(k_cache, rep, axis=1)
        v = (lambda x, n, axis: torch.repeat_interleave(x, n, dim=axis))(v_cache, rep, axis=1)
        scores = torch.einsum("bhqd,bhkd->bhqk", q, k) * (Dh ** -0.5)
        p = _softmax(scores, axis=-1)
        o = torch.einsum("bhqk,bhkd->bhqd", p, v)
        return (lambda x, *d: x.permute(*d))(o, 0, 2, 1, 3).reshape(B, Sq, Hq * Dh) @ wo

    def _B_ref(x, c_kv, w_q, w_uk, w_uv, w_o):
        B, Sq, M = x.shape[0], x.shape[1], x.shape[2]
        Sk = c_kv.shape[1]
        H, D = w_q.shape[1], w_q.shape[2]
        q = torch.einsum("bqm,mhd->bhqd", x, w_q)
        k = torch.einsum("bkc,chd->bhkd", c_kv, w_uk)
        v = torch.einsum("bkc,chd->bhkd", c_kv, w_uv)
        scores = torch.einsum("bhqd,bhkd->bhqk", q, k) * (D ** -0.5)
        off = Sk - Sq
        qi = torch.arange(Sq)[:, None]
        kj = torch.arange(Sk)[None, :]
        cmask = kj <= (qi + off)
        scores = torch.where(cmask[None, None], scores, -1e9)
        p = _softmax(scores, axis=-1)
        ctx = torch.einsum("bhqk,bhkd->bhqd", p, v)
        return torch.einsum("bhqd,hdm->bqm", ctx, w_o)

    x = A_x
    x = x + _A_ref(_layernorm(x, axis=-1), A_k_cache, A_v_cache, A_wq, A_wo)
    x = x + _B_ref(_layernorm(x, axis=-1), B_c_kv, B_w_q, B_w_uk, B_w_uv, B_w_o)
    x = x + _A_ref(_layernorm(x, axis=-1), A_k_cache, A_v_cache, A_wq, A_wo)
    x = x + _B_ref(_layernorm(x, axis=-1), B_c_kv, B_w_q, B_w_uk, B_w_uv, B_w_o)
    return x
```

```asm
; @launch grid=(256,1,1) block=(256,1,1) lds=163840
.amdgcn_target "amdgcn-amd-amdhsa--gfx950"
.text
.globl interleave_layers__gqa_block_cached__compressed_kv_cla__decode_kernel
.p2align 8
.type interleave_layers__gqa_block_cached__compressed_kv_cla__decode_kernel,@function
interleave_layers__gqa_block_cached__compressed_kv_cla__decode_kernel:
    s_load_dwordx2 s[8:9], s[0:1], 8
    s_getpc_b64 s[98:99]
L_pc:
    v_lshlrev_b32 v25, 6, v0
    global_load_dword v88, v25, s[98:99]
    s_cmp_ge_u32 s2, 256
    s_cbranch_scc1 L_exit
    v_readfirstlane_b32 s3, v0
    v_and_b32 v1, 63, v0
    s_mov_b32 s10, 50331648
    s_mov_b32 s11, 0x20000
    s_lshr_b32 s3, s3, 6
m0_start:
    s_getreg_b32 s7, hwreg(HW_REG_XCC_ID, 0, 4)
    s_and_b32 s4, s7, 7
    s_lshr_b32 s5, s2, 3
    v_bfe_u32 v54, v1, 2, 2
    v_lshrrev_b32 v55, 5, v1
    v_lshl_add_u32 v91, v54, 2, v55
    v_mul_u32_u24 v91, 3072, v91
    v_and_b32 v54, 16, v1
    v_lshl_add_u32 v91, v54, 2, v91
    v_and_b32 v55, 3, v1
    v_lshl_add_u32 v91, v55, 4, v91
    s_lshl_b32 s86, s4, 5
    s_add_u32 s86, s86, s5
    s_mul_i32 s79, s86, 196608
    s_mul_i32 s80, s3, 49152
    s_add_u32 s80, s80, s79
    s_waitcnt lgkmcnt(0)
    buffer_load_dwordx4 a[0:3], v91, s[8:11], s80 offen offset:0 nt
    buffer_load_dwordx4 a[4:7], v91, s[8:11], s80 offen offset:128 nt
    buffer_load_dwordx4 a[8:11], v91, s[8:11], s80 offen offset:256 nt
    buffer_load_dwordx4 a[24:27], v91, s[8:11], s80 offen offset:384 nt
    buffer_load_dwordx4 a[28:31], v91, s[8:11], s80 offen offset:512 nt
    buffer_load_dwordx4 a[32:35], v91, s[8:11], s80 offen offset:640 nt
    buffer_load_dwordx4 a[48:51], v91, s[8:11], s80 offen offset:768 nt
    buffer_load_dwordx4 a[52:55], v91, s[8:11], s80 offen offset:896 nt
    s_load_dwordx2 s[56:57], s[0:1], 104
    s_load_dwordx2 s[52:53], s[0:1], 96
    s_load_dwordx2 s[16:17], s[0:1], 24
    s_load_dwordx2 s[44:45], s[0:1], 0
    s_load_dwordx2 s[12:13], s[0:1], 16
    s_load_dwordx2 s[20:21], s[0:1], 32
    s_load_dwordx2 s[24:25], s[0:1], 48
    s_load_dwordx2 s[28:29], s[0:1], 56
    s_load_dwordx2 s[32:33], s[0:1], 64
    s_load_dwordx2 s[36:37], s[0:1], 72
    s_load_dwordx2 s[40:41], s[0:1], 80
    s_load_dwordx2 s[48:49], s[0:1], 88
    v_add_u32 v25, 16384, v25
    v_min_u32 v25, m1_start-L_pc, v25
    global_load_dword v88, v25, s[98:99]
    s_mov_b32 s10, 50331648
    s_mov_b32 s11, 0x20000
    s_mov_b32 s14, 50331648
    s_mov_b32 s15, 0x20000
    s_mov_b32 s18, 7864320
    s_mov_b32 s19, 0x20000
    s_mov_b32 s22, 7864320
    s_mov_b32 s23, 0x20000
    s_mov_b32 s26, 6291456
    s_mov_b32 s27, 0x20000
    s_mov_b32 s30, 7864320
    s_mov_b32 s31, 0x20000
    s_mov_b32 s34, 9437184
    s_mov_b32 s35, 0x20000
    s_mov_b32 s38, 9437184
    s_mov_b32 s39, 0x20000
    s_mov_b32 s42, 7864320
    s_mov_b32 s43, 0x20000
    s_mov_b32 s46, 1280
    s_mov_b32 s47, 0x20000
    s_mov_b32 s50, 1280
    s_mov_b32 s51, 0x20000
    s_mov_b32 s54, 256
    s_mov_b32 s55, 0x20000
    s_mov_b32 s58, 50331648
    s_mov_b32 s59, 0x20000
    s_mov_b32 s60, 0x80000
    s_mov_b32 s88, 0x00010001
    s_mov_b32 s89, 0x00010001
    s_mov_b32 s90, 0x55555555
    s_mov_b32 s91, 0x00005555
    s_mov_b32 s92, 0x01010101
    s_mov_b32 s93, 0x01010101
    s_mov_b32 s94, 0x01030103
    s_mov_b32 s95, 0x01030103
    v_lshlrev_b32 v2, 4, v1
    s_waitcnt lgkmcnt(0)
    s_mov_b32 s99, s7
    s_mov_b32 s7, 0
    v_mov_b32 v64, -1
    v_mov_b32 v65, -1
    v_mov_b32 v66, -1
    v_mov_b32 v67, -1
    s_cmp_lg_u32 s2, 0
    s_nop 0
    s_cbranch_scc1 m0_nolead
    s_lshl_b32 s86, s3, 11
    s_add_u32 s86, s86, 524288
    buffer_store_dwordx4 v[64:67], v2, s[56:59], s86 offen offset:0 sc1
    buffer_store_dwordx4 v[64:67], v2, s[56:59], s86 offen offset:1024 sc1
    s_lshl_b32 s86, s3, 2
    s_mov_b64 exec, 1
    s_waitcnt vmcnt(0)
    buffer_store_dword v64, v2, s[52:55], s86 offen offset:128 sc1
    s_mov_b64 exec, -1
m0_nolead:
    s_lshl_b32 s6, s5, 2
    s_add_u32 s6, s6, s3
    s_sub_u32 s86, s6, 8
    s_cmp_ge_u32 s6, 120
    s_cselect_b32 s6, s86, s6
    s_mul_i32 s86, s6, 2731
    s_lshr_b32 s86, s86, 16
    s_mul_i32 s87, s86, 24
    s_sub_u32 s87, s6, s87
    s_mul_i32 s83, s86, 1572864
    s_mul_i32 s98, s4, 1536
    s_add_u32 s83, s83, s98
    s_lshl_b32 s98, s87, 6
    s_add_u32 s83, s83, s98
    v_lshrrev_b32 v53, 4, v1
    v_mul_u32_u24 v52, 12288, v53
    v_lshlrev_b32 v53, 5, v53
    v_xor_b32 v53, v53, v2
    v_and_b32 v53, 0xf0, v53
    v_add_u32 v52, v52, v53
    v_xor_b32 v53, 128, v52
    s_mul_i32 s98, s3, 393152
    s_add_u32 s98, s98, s83
    s_lshl_b32 vcc_lo, s3, 13
    s_add_u32 m0, vcc_lo, 86016
    s_nop 0
    buffer_load_dwordx4 v52, s[16:19], s98 offen nt lds
    s_add_u32 s98, s98, 49152
    s_add_u32 m0, vcc_lo, 87040
    s_nop 0
    buffer_load_dwordx4 v52, s[16:19], s98 offen nt lds
    s_add_u32 s98, s98, 49152
    s_add_u32 m0, vcc_lo, 88064
    s_nop 0
    buffer_load_dwordx4 v53, s[16:19], s98 offen nt lds
    s_add_u32 s98, s98, 49152
    s_add_u32 m0, vcc_lo, 89088
    s_nop 0
    buffer_load_dwordx4 v53, s[16:19], s98 offen nt lds
    s_add_u32 s98, s98, 49152
    s_add_u32 m0, vcc_lo, 90112
    s_nop 0
    buffer_load_dwordx4 v52, s[16:19], s98 offen nt lds
    s_add_u32 s98, s98, 49152
    s_add_u32 m0, vcc_lo, 91136
    s_nop 0
    buffer_load_dwordx4 v52, s[16:19], s98 offen nt lds
    s_add_u32 s98, s98, 49152
    s_add_u32 m0, vcc_lo, 92160
    s_nop 0
    buffer_load_dwordx4 v53, s[16:19], s98 offen nt lds
    s_add_u32 s98, s98, 49152
    s_add_u32 m0, vcc_lo, 93184
    s_nop 0
    buffer_load_dwordx4 v53, s[16:19], s98 offen nt lds
    s_lshl_b32 s70, s86, 8
    s_mul_i32 s61, s86, 768
    s_mul_i32 s98, s87, 10923
    s_lshr_b32 s98, s98, 16
    s_mul_i32 s86, s98, 3072
    s_add_u32 s61, s61, s86
    s_lshl_b32 s86, s87, 7
    s_add_u32 s61, s61, s86
    s_mul_i32 s86, s4, 36864
    s_add_u32 s61, s61, s86
    s_add_u32 s61, s61, 3604480
    buffer_load_dwordx4 a[56:59], v91, s[8:11], s80 offen offset:1024 nt
    buffer_load_dwordx4 a[72:75], v91, s[8:11], s80 offen offset:1152 nt
    s_memtime s[72:73]
    s_mul_i32 s86, s5, 43
    s_lshr_b32 s86, s86, 7
    s_mul_i32 s86, s86, 3
    s_sub_u32 s86, s5, s86
    s_lshl_b32 s86, s86, 21
    s_xor_b32 s87, s3, s5
    s_and_b32 s87, s87, 1
    s_lshl_b32 s87, s87, 13
    s_add_u32 s86, s86, s87
    s_lshr_b32 s87, s3, 1
    s_mul_i32 s87, s87, 393216
    s_add_u32 s86, s86, s87
    s_add_u32 s86, s86, 4653056
    s_add_u32 s87, s2, 0
    s_and_b32 s98, s87, 63
    s_lshl_b32 s98, s98, 7
    s_and_b32 s87, s87, 192
    s_lshl_b32 s87, s87, 8
    s_add_u32 s87, s87, s98
    s_add_u32 s62, s87, s86
    s_add_u32 s86, s86, 65536
    s_add_u32 s87, s2, 73
    s_and_b32 s98, s87, 63
    s_lshl_b32 s98, s98, 7
    s_and_b32 s87, s87, 192
    s_lshl_b32 s87, s87, 8
    s_add_u32 s87, s87, s98
    s_add_u32 s63, s87, s86
    s_add_u32 s86, s86, 65536
    s_add_u32 s87, s2, 146
    s_and_b32 s98, s87, 63
    s_lshl_b32 s98, s98, 7
    s_and_b32 s87, s87, 192
    s_lshl_b32 s87, s87, 8
    s_add_u32 s87, s87, s98
    s_add_u32 s64, s87, s86
    s_add_u32 s86, s86, 65536
    s_add_u32 s87, s2, 219
    s_and_b32 s98, s87, 63
    s_lshl_b32 s98, s98, 7
    s_and_b32 s87, s87, 192
    s_lshl_b32 s87, s87, 8
    s_add_u32 s87, s87, s98
    s_add_u32 s65, s87, s86
    s_add_u32 s86, s86, 65536
    s_add_u32 s87, s2, 292
    s_and_b32 s98, s87, 63
    s_lshl_b32 s98, s98, 7
    s_and_b32 s87, s87, 192
    s_lshl_b32 s87, s87, 8
    s_add_u32 s87, s87, s98
    s_add_u32 s66, s87, s86
    s_add_u32 s86, s86, 65536
    s_add_u32 s87, s2, 365
    s_and_b32 s98, s87, 63
    s_lshl_b32 s98, s98, 7
    s_and_b32 s87, s87, 192
    s_lshl_b32 s87, s87, 8
    s_add_u32 s87, s87, s98
    s_add_u32 s67, s87, s86
    s_waitcnt lgkmcnt(0)
    s_buffer_load_dword s62, s[56:59], s62 glc
    s_buffer_load_dword s63, s[56:59], s63 glc
    s_buffer_load_dword s64, s[56:59], s64 glc
    s_buffer_load_dword s65, s[56:59], s65 glc
    s_buffer_load_dword s66, s[56:59], s66 glc
    s_buffer_load_dword s67, s[56:59], s67 glc
    s_waitcnt lgkmcnt(1)
    s_memtime s[74:75]
    v_lshlrev_b32 v17, 2, v1
    v_and_b32 v23, 15, v1
    v_and_b32 v16, 48, v1
    v_lshrrev_b32 v24, 4, v1
    v_bfe_u32 v25, v1, 2, 2
    v_and_b32 v26, 3, v1
    v_and_b32 v27, 7, v1
    v_lshl_add_u32 v20, v27, 2, v24
    v_lshlrev_b32 v20, 1, v20
    v_lshrrev_b32 v18, 3, v1
    v_lshlrev_b32 v18, 7, v18
    v_lshl_add_u32 v18, v27, 1, v18
    v_mul_u32_u24 v3, 16640, v25
    v_lshl_add_u32 v3, v26, 4, v3
    v_lshl_add_u32 v3, v24, 6, v3
    s_lshl_b32 s86, s3, 11
    s_add_u32 s86, s86, 155648
    v_lshlrev_b32 v22, 2, v16
    v_xor_b32 v22, v22, v2
    v_add_u32 v22, s86, v22
    v_lshlrev_b32 v14, 3, v1
    v_add_u32 v14, s86, v14
    v_lshl_add_u32 v27, v24, 3, v25
    v_lshlrev_b32 v27, 6, v27
    v_lshl_add_u32 v27, v26, 3, v27
    s_mul_i32 s87, s3, 12288
    v_add_u32 v21, s87, v27
    s_lshl_b32 s87, s3, 6
    v_lshlrev_b32 v27, 3, v26
    v_add_u32 v27, s87, v27
    v_lshlrev_b32 v28, 5, v25
    v_xor_b32 v27, v27, v28
    v_and_b32 v28, 16, v1
    v_lshlrev_b32 v28, 3, v28
    v_xor_b32 v27, v27, v28
    v_lshl_add_u32 v28, v24, 3, v25
    v_lshl_add_u32 v9, v28, 8, v27
    v_add_u32 v9, 86016, v9
    v_and_b32 v27, 1, v24
    v_lshl_add_u32 v27, v27, 2, v26
    v_lshlrev_b32 v27, 4, v27
    v_add_u32 v27, s86, v27
    v_lshrrev_b32 v28, 1, v24
    v_mov_b32 v29, 151808
    v_cmp_eq_u32 vcc, v25, v28
    s_nop 1
    v_cndmask_b32 v5, v29, v27, vcc
    v_add_u32 v28, 2, v28
    v_cmp_eq_u32 vcc, v25, v28
    s_nop 1
    v_cndmask_b32 v6, v29, v27, vcc
    s_mul_i32 s87, s3, 12288
    v_add_u32 v10, v16, v25
    v_mul_u32_u24 v10, 96, v10
    v_lshl_add_u32 v10, v26, 3, v10
    s_and_b32 s98, s3, 1
    s_mul_i32 s98, s98, 24576
    s_add_u32 s98, s98, 6144
    v_add_u32 v10, s98, v10
    v_and_b32 v27, 14, v23
    v_lshlrev_b32 v27, 3, v27
    v_xor_b32 v27, v27, v16
    v_lshl_add_u32 v4, v23, 7, v27
    v_add_u32 v4, s87, v4
    v_and_b32 v11, 4, v1
    v_lshlrev_b32 v11, 8, v11
    v_lshl_add_u32 v11, v26, 2, v11
    v_lshrrev_b32 v27, 3, v1
    v_lshl_add_u32 v11, v27, 4, v11
    s_and_b32 s87, s3, 1
    s_lshl_b32 s87, s87, 3
    v_lshrrev_b32 v12, 3, v1
    v_add_u32 v12, s87, v12
    v_and_b32 v27, 7, v1
    v_lshlrev_b32 v28, 1, v27
    v_xor_b32 v12, v12, v28
    v_lshlrev_b32 v12, 4, v12
    v_lshl_add_u32 v12, v27, 9, v12
    s_lshr_b32 s87, s3, 1
    s_mul_i32 s87, s87, 24576
    v_add_u32 v12, s87, v12
    v_lshrrev_b32 v15, 1, v1
    v_lshl_add_u32 v27, v24, 2, 32
    v_cmp_eq_u32 vcc, 1, v23
    s_nop 1
    v_cndmask_b32 v15, v15, v27, vcc
    v_and_b32 v27, 0x30, v15
    v_and_b32 v15, 15, v15
    v_lshl_add_u32 v15, v27, 2, v15
    v_mov_b32 v52, 0x3f803f80
    v_cmp_eq_u32 vcc, 1, v23
    s_nop 1
    v_cndmask_b32 v24, 0, v52, vcc
    v_mov_b32 v25, v24
    v_mov_b32 v26, v24
    v_mov_b32 v27, v24
    v_mov_b32 v28, v24
    v_mov_b32 v29, v24
    v_mov_b32 v30, v24
    v_mov_b32 v31, v24
    v_mov_b32 v32, v24
    v_mov_b32 v33, v24
    v_mov_b32 v34, v24
    v_mov_b32 v35, v24
    v_mov_b32 v36, v24
    v_mov_b32 v37, v24
    v_mov_b32 v38, v24
    v_mov_b32 v39, v24
    v_mov_b32 v40, 0
    v_mov_b32 v41, 0
    v_mov_b32 v42, 0
    v_mov_b32 v43, 0
    s_mov_b64 exec, s[88:89]
    buffer_load_dwordx4 v[24:27], v16, s[44:47], s70 offen offset:0
    buffer_load_dwordx4 v[28:31], v16, s[44:47], s70 offen offset:64
    buffer_load_dwordx4 v[32:35], v16, s[44:47], s70 offen offset:128
    buffer_load_dwordx4 v[36:39], v16, s[44:47], s70 offen offset:192
    s_mov_b64 exec, -1
    buffer_load_dwordx4 v[56:59], v2, s[44:47], 0 offen
    buffer_load_dwordx4 v[60:63], v2, s[44:47], 0 offen offset:1024
    s_lshl_b32 s0, s5, 2
    s_add_u32 s0, s0, s3
    s_sub_u32 s0, s0, 108
    s_min_u32 s86, s0, 19
    s_lshl_b32 s86, s86, 6
    buffer_load_ushort v19, v20, s[44:47], s86 offen
    s_lshl_b32 s86, s5, 2
    s_add_u32 s86, s86, s3
    s_mul_i32 s86, s86, 144
    s_mul_i32 s87, s4, 36864
    s_add_u32 s86, s86, s87
    s_add_u32 s86, s86, 3619840
    s_mov_b64 exec, 0x1ff
    buffer_store_dwordx4 v[64:67], v2, s[56:59], s86 offen
    s_mov_b64 exec, -1
    s_waitcnt vmcnt(21)
    buffer_load_dwordx4 a[76:79], v91, s[8:11], s80 offen offset:1280 nt
    s_waitcnt vmcnt(21)
    buffer_load_dwordx4 a[80:83], v91, s[8:11], s80 offen offset:1408 nt
    s_waitcnt vmcnt(21)
    buffer_load_dwordx4 a[96:99], v91, s[8:11], s80 offen offset:1536 nt
    s_waitcnt vmcnt(21)
    buffer_load_dwordx4 a[100:103], v91, s[8:11], s80 offen offset:1664 nt
    s_waitcnt vmcnt(21)
    buffer_load_dwordx4 a[104:107], v91, s[8:11], s80 offen offset:1792 nt
    s_waitcnt vmcnt(21)
    buffer_load_dwordx4 a[120:123], v91, s[8:11], s80 offen offset:1920 nt
    v_mov_b32 v68, 0
    v_mov_b32 v69, 0
    v_mov_b32 v70, 0
    v_mov_b32 v71, 0
    s_lshl_b32 s86, s3, 10
    s_add_u32 s86, s86, 151552
    v_add_u32 v54, s86, v2
    ds_write_b128 v54, v[68:71]
    s_waitcnt lgkmcnt(0)
    s_sub_u32 s74, s74, s72
    s_lshl_b32 s86, s3, 2
    s_add_u32 s86, s86, 157184
    v_mov_b32 v54, s86
    v_mov_b32 v55, s74
    ds_write_b32 v54, v55
    s_lshr_b32 s86, s5, 3
    s_and_b32 s87, s5, 7
    s_lshl_b32 s98, s4, 2
    s_add_u32 s98, s98, s86
    s_mul_i32 vcc_hi, s4, 36864
    s_mul_i32 s85, s86, 3840
    s_add_u32 s85, s85, vcc_hi
    s_add_u32 s85, s85, 3604480
    s_sub_u32 s62, s85, 2097152
    s_lshl_b32 s64, s86, 8
    s_add_u32 s64, s64, vcc_hi
    s_add_u32 s64, s64, 3632128
    s_lshl_b32 s63, s87, 2
    s_add_u32 s63, s63, s3
    s_lshl_b32 s63, s63, 3
    s_add_u32 s63, s63, s64
    s_mul_i32 s1, s3, 3840
    s_add_u32 s1, s1, vcc_hi
    s_add_u32 s1, s1, 3604480
    s_add_u32 s66, vcc_hi, 3619840
    s_add_u32 s72, vcc_hi, 1539072
    s_add_u32 s76, vcc_hi, 3932160
    s_lshl_b32 vcc_lo, s4, 2
    s_add_u32 vcc_lo, vcc_lo, s3
    s_mul_i32 s84, vcc_lo, 384
    s_mul_i32 vcc_lo, s5, 294912
    s_add_u32 s84, s84, vcc_lo
    s_mul_i32 s73, s4, 16640
    s_mul_i32 vcc_lo, s5, 192
    s_add_u32 s73, s73, vcc_lo
    s_lshl_b32 vcc_lo, s3, 4
    s_add_u32 s73, s73, vcc_lo
    s_add_u32 s73, s73, 2097152
    s_lshl_b32 s65, s87, 4
    s_add_u32 s65, s65, s66
    s_mul_i32 vcc_lo, s86, 3072
    s_add_u32 s65, s65, vcc_lo
    s_mul_i32 vcc_lo, s3, 768
    s_add_u32 s65, s65, vcc_lo
    s_and_b32 vcc_lo, s5, 7
    s_lshl_b32 vcc_lo, vcc_lo, 1
    v_add_u32 v13, vcc_lo, v23
    v_and_b32 v13, 15, v13
    v_lshlrev_b32 v13, 4, v13
    v_and_b32 v7, 3, v1
    v_lshl_add_u32 v7, v7, 10, v16
    v_add_u32 v7, 151552, v7
    s_mul_i32 vcc_lo, s3, 1280
    s_add_u32 vcc_lo, vcc_lo, 151552
    v_and_b32 v8, 0xf0, v17
    v_add_u32 v8, vcc_lo, v8
    s_mul_i32 s86, s6, 3277
    s_lshr_b32 s86, s86, 16
    s_mul_i32 s87, s86, 20
    s_sub_u32 s87, s6, s87
    s_lshl_b32 vcc_lo, s86, 11
    s_add_u32 s66, s66, vcc_lo
    s_lshl_b32 s67, s87, 14
    s_mul_i32 vcc_lo, s4, 768
    s_add_u32 s67, s67, vcc_lo
    s_lshl_b32 vcc_lo, s86, 7
    s_add_u32 s67, s67, vcc_lo
    s_add_u32 s67, s67, 2228224
    s_lshl_b32 s68, s0, 14
    s_add_u32 s68, s68, 2228224
    s_lshr_b32 vcc_lo, s4, 2
    s_lshl_b32 vcc_lo, vcc_lo, 13
    s_add_u32 s68, s68, vcc_lo
    s_add_u32 s74, vcc_lo, 2097152
    s_lshl_b32 s69, s0, 6
    s_add_u32 s69, s69, s72
    s_add_u32 s69, s69, 2097152
    s_lshl_b32 s71, s0, 3
    s_add_u32 s71, s71, s72
    s_add_u32 s71, s71, 2098432
    s_mul_i32 vcc_lo, s3, 1536
    s_add_u32 s74, s74, vcc_lo
    s_lshr_b32 s86, s5, 2
    s_and_b32 s87, s5, 3
    s_lshl_b32 s75, s87, 8
    s_add_u32 s75, s75, s76
    s_lshr_b32 vcc_lo, s86, 2
    s_lshl_b32 vcc_lo, vcc_lo, 10
    s_add_u32 s75, s75, vcc_lo
    s_and_b32 vcc_lo, s86, 3
    s_lshl_b32 vcc_lo, vcc_lo, 2
    s_add_u32 s75, s75, vcc_lo
    s_sub_u32 s82, s76, 32768
    s_lshl_b32 s81, s86, 11
    s_add_u32 s81, s81, s82
    s_lshl_b32 vcc_lo, s87, 8
    s_add_u32 s81, s81, vcc_lo
    s_lshr_b32 s86, s3, 1
    s_and_b32 s87, s3, 1
    s_and_b32 s98, s5, 1
    s_lshl_b32 vcc_lo, s86, 14
    s_add_u32 s81, s81, vcc_lo
    s_add_u32 s82, s82, vcc_lo
    s_lshl_b32 vcc_lo, s87, 7
    s_add_u32 s81, s81, vcc_lo
    s_add_u32 s75, s75, vcc_lo
    s_lshl_b32 vcc_lo, s86, 11
    s_add_u32 s75, s75, vcc_lo
    s_add_u32 s76, s76, vcc_lo
    s_lshl_b32 vcc_lo, s87, 12
    s_add_u32 s82, s82, vcc_lo
    s_lshl_b32 vcc_lo, s98, 13
    s_add_u32 s82, s82, vcc_lo
    s_lshl_b32 vcc_lo, s98, 10
    s_add_u32 s76, s76, vcc_lo
    s_lshl_b32 s86, s4, 3
    s_lshl_b32 s98, s98, 2
    s_add_u32 s86, s86, s98
    s_add_u32 s86, s86, s3
    s_mul_i32 s77, s86, 98304
    s_lshr_b32 s86, s5, 1
    s_mul_i32 s86, s86, 96
    s_add_u32 s77, s77, s86
    v_and_b32 v54, 8, v1
    v_mul_u32_u24 v54, 1008, v54
    v_add_u32 v54, v54, v2
    s_mov_b64 exec, 0xffff
    buffer_store_dwordx4 v[64:67], v54, s[56:59], s67 offen sc1
    s_mov_b64 exec, -1
    s_mul_i32 s86, s3, 6144
    s_add_u32 s79, s79, s86
    s_waitcnt vmcnt(8)
    v_lshlrev_b32 v19, 16, v19
    v_mov_b32 v52, 0
    v_mov_b32 v53, 0
    v_lshlrev_b32 v54, 16, v56
    v_and_b32 v55, 0xffff0000, v56
    v_add_f32 v52, v52, v54
    v_fmac_f32 v53, v54, v54
    v_add_f32 v52, v52, v55
    v_fmac_f32 v53, v55, v55
    v_lshlrev_b32 v54, 16, v57
    v_and_b32 v55, 0xffff0000, v57
    v_add_f32 v52, v52, v54
    v_fmac_f32 v53, v54, v54
    v_add_f32 v52, v52, v55
    v_fmac_f32 v53, v55, v55
    v_lshlrev_b32 v54, 16, v58
    v_and_b32 v55, 0xffff0000, v58
    v_add_f32 v52, v52, v54
    v_fmac_f32 v53, v54, v54
    v_add_f32 v52, v52, v55
    v_fmac_f32 v53, v55, v55
    v_lshlrev_b32 v54, 16, v59
    v_and_b32 v55, 0xffff0000, v59
    v_add_f32 v52, v52, v54
    v_fmac_f32 v53, v54, v54
    v_add_f32 v52, v52, v55
    v_fmac_f32 v53, v55, v55
    v_lshlrev_b32 v54, 16, v60
    v_and_b32 v55, 0xffff0000, v60
    v_add_f32 v52, v52, v54
    v_fmac_f32 v53, v54, v54
    v_add_f32 v52, v52, v55
    v_fmac_f32 v53, v55, v55
    v_lshlrev_b32 v54, 16, v61
    v_and_b32 v55, 0xffff0000, v61
    v_add_f32 v52, v52, v54
    v_fmac_f32 v53, v54, v54
    v_add_f32 v52, v52, v55
    v_fmac_f32 v53, v55, v55
    v_lshlrev_b32 v54, 16, v62
    v_and_b32 v55, 0xffff0000, v62
    v_add_f32 v52, v52, v54
    v_fmac_f32 v53, v54, v54
    v_add_f32 v52, v52, v55
    v_fmac_f32 v53, v55, v55
    v_lshlrev_b32 v54, 16, v63
    v_and_b32 v55, 0xffff0000, v63
    v_add_f32 v52, v52, v54
    v_fmac_f32 v53, v54, v54
    v_add_f32 v52, v52, v55
    v_fmac_f32 v53, v55, v55
    s_barrier
    v_xor_b32 v54, 32, v9
    ds_read_b64_tr_b16 v[56:57], v9 offset:0
    ds_read_b64_tr_b16 v[58:59], v9 offset:1024
    ds_read_b64_tr_b16 v[60:61], v54 offset:0
    ds_read_b64_tr_b16 v[62:63], v54 offset:1024
    ds_read_b64_tr_b16 v[64:65], v9 offset:8192
    ds_read_b64_tr_b16 v[66:67], v9 offset:9216
    ds_read_b64_tr_b16 v[68:69], v54 offset:8192
    ds_read_b64_tr_b16 v[70:71], v54 offset:9216
    ds_read_b64_tr_b16 v[72:73], v9 offset:16384
    ds_read_b64_tr_b16 v[74:75], v9 offset:17408
    ds_read_b64_tr_b16 v[76:77], v54 offset:16384
    ds_read_b64_tr_b16 v[78:79], v54 offset:17408
    ds_read_b64_tr_b16 v[80:81], v9 offset:24576
    ds_read_b64_tr_b16 v[82:83], v9 offset:25600
    ds_read_b64_tr_b16 v[84:85], v54 offset:24576
    ds_read_b64_tr_b16 v[86:87], v54 offset:25600
    v_add_f32_dpp v52, v52, v52 row_ror:8 row_mask:0xf bank_mask:0xf
    v_add_f32_dpp v53, v53, v53 row_ror:8 row_mask:0xf bank_mask:0xf
    s_nop 0
    v_add_f32_dpp v52, v52, v52 row_ror:4 row_mask:0xf bank_mask:0xf
    v_add_f32_dpp v53, v53, v53 row_ror:4 row_mask:0xf bank_mask:0xf
    s_nop 0
    v_add_f32_dpp v52, v52, v52 row_ror:2 row_mask:0xf bank_mask:0xf
    v_add_f32_dpp v53, v53, v53 row_ror:2 row_mask:0xf bank_mask:0xf
    s_nop 0
    v_add_f32_dpp v52, v52, v52 row_ror:1 row_mask:0xf bank_mask:0xf
    v_add_f32_dpp v53, v53, v53 row_ror:1 row_mask:0xf bank_mask:0xf
    v_mov_b32 v54, v52
    s_nop 1
    v_permlane16_swap_b32 v52, v54
    v_add_f32 v52, v52, v54
    v_mov_b32 v55, v53
    s_nop 1
    v_permlane16_swap_b32 v53, v55
    v_add_f32 v53, v53, v55
    v_mov_b32 v54, v52
    s_nop 1
    v_permlane32_swap_b32 v52, v54
    v_add_f32 v52, v52, v54
    v_mov_b32 v55, v53
    s_nop 1
    v_permlane32_swap_b32 v53, v55
    v_add_f32 v53, v53, v55
    v_mul_f32 v52, 0x3acccccd, v52
    v_mul_f32 v53, 0x3acccccd, v53
    v_fma_f32 v53, -v52, v52, v53
    s_mov_b32 s86, 0x3727c5ac
    v_add_f32 v53, s86, abs(v53)
    v_rsq_f32 v53, v53
    s_waitcnt lgkmcnt(0)
    v_mfma_f32_16x16x32_bf16 v[44:47], v[24:27], v[56:59], 0
    v_mfma_f32_16x16x32_bf16 v[48:51], v[24:27], v[60:63], 0
    v_mfma_f32_16x16x32_bf16 v[44:47], v[28:31], v[64:67], v[44:47]
    v_mfma_f32_16x16x32_bf16 v[48:51], v[28:31], v[68:71], v[48:51]
    v_mfma_f32_16x16x32_bf16 v[44:47], v[32:35], v[72:75], v[44:47]
    v_mfma_f32_16x16x32_bf16 v[48:51], v[32:35], v[76:79], v[48:51]
    v_mfma_f32_16x16x32_bf16 v[44:47], v[36:39], v[80:83], v[44:47]
    v_mfma_f32_16x16x32_bf16 v[48:51], v[36:39], v[84:87], v[48:51]
    s_nop 6
    v_fma_f32 v54, -v52, v45, v44
    v_fma_f32 v55, -v52, v49, v48
    v_mul_f32 v54, v54, v53
    v_mul_f32 v55, v55, v53
    s_nop 1
    v_permlane16_swap_b32 v54, v55
    s_mov_b32 exec_hi, 0
    s_sub_u32 s86, s61, 2097152
    buffer_store_dword v54, v17, s[56:59], s86 offen
    s_mov_b64 exec, -1
    s_add_u32 s70, s70, s72
    s_add_u32 s72, s72, 1280
    buffer_load_dwordx4 a[124:127], v91, s[8:11], s80 offen offset:2048 nt
    buffer_load_dwordx4 a[128:131], v91, s[8:11], s80 offen offset:2176 nt
    buffer_load_dwordx4 a[144:147], v91, s[8:11], s80 offen offset:2304 nt
    buffer_load_dwordx4 a[148:151], v91, s[8:11], s80 offen offset:2432 nt
    s_mov_b64 exec, 1
    buffer_load_dwordx4 v[24:27], v2, s[52:55], 0 offen offset:128 sc1
    s_mov_b64 exec, -1
    buffer_load_dwordx4 a[152:155], v91, s[8:11], s80 offen offset:2560 nt
    buffer_load_dwordx4 a[168:171], v91, s[8:11], s80 offen offset:2688 nt
    buffer_load_dwordx4 a[172:175], v91, s[8:11], s80 offen offset:2816 nt
    buffer_load_dwordx4 a[176:179], v91, s[8:11], s80 offen offset:2944 nt
    s_add_u32 s80, s80, 6144
    s_waitcnt vmcnt(16)
    buffer_load_dwordx4 a[12:15], v91, s[8:11], s80 offen offset:0 nt
    s_waitcnt vmcnt(16)
    buffer_load_dwordx4 a[16:19], v91, s[8:11], s80 offen offset:128 nt
    s_waitcnt vmcnt(16)
    buffer_load_dwordx4 a[20:23], v91, s[8:11], s80 offen offset:256 nt
    s_waitcnt vmcnt(16)
    buffer_load_dwordx4 a[36:39], v91, s[8:11], s80 offen offset:384 nt
    s_waitcnt vmcnt(16)
    buffer_load_dwordx4 a[40:43], v91, s[8:11], s80 offen offset:512 nt
    s_waitcnt vmcnt(16)
    buffer_load_dwordx4 a[44:47], v91, s[8:11], s80 offen offset:640 nt
    s_waitcnt vmcnt(14)
    buffer_load_dwordx4 a[60:63], v91, s[8:11], s80 offen offset:768 nt
    s_waitcnt vmcnt(14)
    buffer_load_dwordx4 a[64:67], v91, s[8:11], s80 offen offset:896 nt
    s_waitcnt vmcnt(14)
    buffer_load_dwordx4 a[68:71], v91, s[8:11], s80 offen offset:1024 nt
    s_mul_i32 s86, s3, 6144
    v_add_u32 v86, s86, v2
    v_lshrrev_b32 v87, 4, v1
    v_bfe_u32 v54, v1, 2, 2
    v_lshl_add_u32 v87, v87, 3, v54
    v_mul_u32_u24 v87, 384, v87
    v_and_b32 v54, 3, v1
    v_lshl_add_u32 v87, v54, 3, v87
    s_mul_i32 s86, s3, 96
    v_add_u32 v87, s86, v87
    s_waitcnt vmcnt(13)
    s_barrier
    s_mov_b64 exec, 1
m0_go_chk:
    v_and_b32 v24, v24, v25
    v_and_b32 v26, v26, v27
    v_and_b32 v24, v24, v26
    v_cmp_ne_u32 vcc, -1, v24
    s_cbranch_vccnz m0_go_slow
m0_go_ok:
    s_cmp_lg_u32 s3, 0
    s_nop 2
    s_cbranch_scc1 m0_noclaim
    s_lshl_b32 s86, 1, s99
    s_and_b32 s86, s86, 0xff
    v_mov_b32 v24, s86
    v_mov_b32 v25, 157184
    ds_read_b128 v[28:31], v25
    s_mul_i32 s86, s5, 43
    s_lshr_b32 s86, s86, 7
    s_mul_i32 s86, s86, 3
    s_sub_u32 s86, s5, s86
    s_lshl_b32 s86, s86, 3
    s_lshl_b32 s86, 0x100, s86
    s_lshr_b32 s87, s4, 2
    s_xor_b32 s87, s87, s5
    s_bitcmp1_b32 s87, 0
    s_cselect_b32 s87, 0, s86
    s_cselect_b32 s98, s86, 0
    v_mov_b32 v26, s87
    v_mov_b32 v27, s98
    s_waitcnt lgkmcnt(0)
    v_add_u32 v28, v28, v30
    v_add_u32 v29, v29, v31
    v_cmp_gt_u32 vcc, v28, v29
    s_nop 1
    v_cndmask_b32 v26, v27, v26, vcc
    v_or_b32 v24, v24, v26
    s_lshl_b32 s86, s2, 5
    s_add_u32 s86, s86, 524288
    buffer_store_dword v24, v2, s[56:59], s86 offen sc1
m0_noclaim:
    s_mov_b64 exec, -1
    buffer_load_dwordx4 a[84:87], v91, s[8:11], s80 offen offset:1152 nt
    s_waitcnt vmcnt(13)
    buffer_load_dwordx4 a[88:91], v91, s[8:11], s80 offen offset:1280 nt
    s_waitcnt vmcnt(13)
    buffer_load_dwordx4 a[92:95], v91, s[8:11], s80 offen offset:1408 nt
    s_waitcnt vmcnt(13)
    buffer_load_dwordx4 a[108:111], v91, s[8:11], s80 offen offset:1536 nt
    s_waitcnt vmcnt(13)
    buffer_load_dwordx4 a[112:115], v91, s[8:11], s80 offen offset:1664 nt
    s_waitcnt vmcnt(13)
    buffer_load_dwordx4 a[116:119], v91, s[8:11], s80 offen offset:1792 nt
    s_waitcnt vmcnt(13)
    buffer_load_dwordx4 a[132:135], v91, s[8:11], s80 offen offset:1920 nt
    s_waitcnt vmcnt(13)
    buffer_load_dwordx4 a[136:139], v91, s[8:11], s80 offen offset:2048 nt
    s_waitcnt vmcnt(13)
    buffer_load_dwordx4 a[140:143], v91, s[8:11], s80 offen offset:2176 nt
    s_waitcnt vmcnt(13)
    buffer_load_dwordx4 a[156:159], v91, s[8:11], s80 offen offset:2304 nt
    s_waitcnt vmcnt(13)
    buffer_load_dwordx4 a[160:163], v91, s[8:11], s80 offen offset:2432 nt
    s_waitcnt vmcnt(13)
    buffer_load_dwordx4 a[164:167], v91, s[8:11], s80 offen offset:2560 nt
    s_waitcnt vmcnt(13)
    buffer_load_dwordx4 a[180:183], v91, s[8:11], s80 offen offset:2688 nt
    s_waitcnt vmcnt(13)
    buffer_load_dwordx4 a[184:187], v91, s[8:11], s80 offen offset:2816 nt
    s_waitcnt vmcnt(13)
    buffer_load_dwordx4 a[188:191], v91, s[8:11], s80 offen offset:2944 nt
    s_mul_i32 s86, s6, 3277
    s_lshr_b32 s86, s86, 16
    s_mul_i32 s87, s86, 20
    s_sub_u32 s87, s6, s87
    s_mul_i32 s80, s4, 983040
    s_mul_i32 s86, s86, 163840
    s_add_u32 s80, s80, s86
    s_lshl_b32 s87, s87, 6
    s_add_u32 s80, s80, s87
    s_waitcnt vmcnt(13)
    buffer_load_dwordx4 v[92:95], v2, s[12:15], s79 offen offset:0 nt
    s_waitcnt vmcnt(13)
    buffer_load_dwordx4 v[96:99], v2, s[12:15], s79 offen offset:1024 nt
    s_waitcnt vmcnt(13)
    buffer_load_dwordx4 v[100:103], v2, s[12:15], s79 offen offset:2048 nt
    s_waitcnt vmcnt(13)
    buffer_load_dwordx4 v[104:107], v2, s[12:15], s79 offen offset:3072 nt
    s_add_u32 s79, s79, 4096
    s_waitcnt vmcnt(13)
    buffer_load_dwordx4 v[108:111], v2, s[12:15], s79 offen offset:0 nt
    s_waitcnt vmcnt(13)
    buffer_load_dwordx4 v[112:115], v2, s[12:15], s79 offen offset:1024 nt
    v_lshlrev_b32 v36, 5, v1
    s_mov_b32 s86, 524288
    buffer_load_dword v88, v36, s[56:59], s86 offen sc1
    s_add_u32 s86, s86, 2048
    buffer_load_dword v89, v36, s[56:59], s86 offen sc1
    s_add_u32 s86, s86, 2048
    buffer_load_dword v90, v36, s[56:59], s86 offen sc1
    s_add_u32 s86, s86, 2048
    buffer_load_dword v91, v36, s[56:59], s86 offen sc1
    s_add_u32 s79, s79, 20480
    s_waitcnt vmcnt(17)
    buffer_load_dwordx4 v[116:119], v2, s[12:15], s79 offen offset:0 nt
    s_waitcnt vmcnt(17)
    buffer_load_dwordx4 v[120:123], v2, s[12:15], s79 offen offset:1024 nt
    s_waitcnt vmcnt(17)
    buffer_load_dwordx4 v[124:127], v2, s[12:15], s79 offen offset:2048 nt
    s_waitcnt vmcnt(17)
    buffer_load_dwordx4 v[128:131], v2, s[12:15], s79 offen offset:3072 nt
    s_add_u32 s79, s79, 4096
    s_waitcnt vmcnt(17)
    buffer_load_dwordx4 v[132:135], v2, s[12:15], s79 offen offset:0 nt
    s_waitcnt vmcnt(17)
    buffer_load_dwordx4 v[136:139], v2, s[12:15], s79 offen offset:1024 nt
    s_add_u32 s79, s79, 20480
    s_waitcnt vmcnt(17)
    buffer_load_dwordx4 v[140:143], v2, s[12:15], s79 offen offset:0 nt
    s_waitcnt vmcnt(17)
    buffer_load_dwordx4 v[144:147], v2, s[12:15], s79 offen offset:1024 nt
    s_waitcnt vmcnt(17)
    buffer_load_dwordx4 v[148:151], v2, s[12:15], s79 offen offset:2048 nt
    s_waitcnt vmcnt(17)
    buffer_load_dwordx4 v[152:155], v2, s[12:15], s79 offen offset:3072 nt
    s_add_u32 s79, s79, 4096
    s_waitcnt vmcnt(17)
    buffer_load_dwordx4 v[156:159], v2, s[12:15], s79 offen offset:0 nt
    s_waitcnt vmcnt(17)
    buffer_load_dwordx4 v[160:163], v2, s[12:15], s79 offen offset:1024 nt
    s_waitcnt vmcnt(12)
m0_bar_chk:
    v_and_b32 v40, 0xff, v88
    v_and_b32 v41, 0xff, v89
    v_and_b32 v42, 0xff, v90
    v_and_b32 v43, 0xff, v91
    v_add_u32_dpp v40, v40, v40 quad_perm:[1,0,3,2] row_mask:0xf bank_mask:0xf
    v_add_u32_dpp v41, v41, v41 quad_perm:[1,0,3,2] row_mask:0xf bank_mask:0xf
    v_add_u32_dpp v42, v42, v42 quad_perm:[1,0,3,2] row_mask:0xf bank_mask:0xf
    v_add_u32_dpp v43, v43, v43 quad_perm:[1,0,3,2] row_mask:0xf bank_mask:0xf
    v_add_u32_dpp v40, v40, v40 quad_perm:[2,3,0,1] row_mask:0xf bank_mask:0xf
    v_add_u32_dpp v41, v41, v41 quad_perm:[2,3,0,1] row_mask:0xf bank_mask:0xf
    v_add_u32_dpp v42, v42, v42 quad_perm:[2,3,0,1] row_mask:0xf bank_mask:0xf
    v_add_u32_dpp v43, v43, v43 quad_perm:[2,3,0,1] row_mask:0xf bank_mask:0xf
    v_add_u32_dpp v40, v40, v40 row_half_mirror row_mask:0xf bank_mask:0xf
    v_add_u32_dpp v41, v41, v41 row_half_mirror row_mask:0xf bank_mask:0xf
    v_add_u32_dpp v42, v42, v42 row_half_mirror row_mask:0xf bank_mask:0xf
    v_add_u32_dpp v43, v43, v43 row_half_mirror row_mask:0xf bank_mask:0xf
    v_mov_b32 v39, 0xff
    v_xor_b32 v40, v40, v39
    v_xor_b32 v41, v41, v39
    v_xor_b32 v42, v42, v39
    v_xor_b32 v43, v43, v39
    v_or3_b32 v40, v40, v41, v42
    v_or_b32 v40, v40, v43
    v_max3_u32 v41, v88, v89, v90
    v_max_u32 v41, v41, v91
    v_cmp_eq_u32 s[100:101], -1, v41
    v_cmp_ne_u32 vcc, 0, v40
    s_or_b64 vcc, vcc, s[100:101]
    s_cbranch_scc1 m0_bar_slow
m0_bar_ok:
    s_mov_b32 s100, 0x00020002
    s_mov_b32 s101, 0x00020002
    v_lshrrev_b32 v40, 8, v88
    v_lshrrev_b32 v41, 8, v89
    v_lshrrev_b32 v42, 8, v90
    v_lshrrev_b32 v43, 8, v91
    v_add3_u32 v40, v40, v41, v42
    v_add_u32 v40, v40, v43
    s_nop 1
    v_add_u32_dpp v40, v40, v40 row_ror:8 row_mask:0xf bank_mask:0xf
    s_nop 1
    v_add_u32_dpp v40, v40, v40 row_ror:4 row_mask:0xf bank_mask:0xf
    s_nop 1
    v_add_u32_dpp v40, v40, v40 row_ror:2 row_mask:0xf bank_mask:0xf
    s_nop 1
    v_add_u32_dpp v40, v40, v40 row_ror:1 row_mask:0xf bank_mask:0xf
    v_mov_b32 v41, v40
    s_nop 1
    v_permlane16_swap_b32 v40, v41
    v_add_u32 v40, v40, v41
    v_mov_b32 v41, v40
    s_nop 1
    v_permlane32_swap_b32 v40, v41
    v_add_u32 v40, v40, v41
    s_nop 0
    v_readfirstlane_b32 s86, v40
    s_bfe_u32 s87, s86, 0x80000
    s_sub_i32 s87, s87, 44
    s_bfe_u32 vcc_lo, s86, 0x80008
    s_sub_i32 vcc_lo, vcc_lo, 44
    s_bfe_u32 vcc_hi, s86, 0x80010
    s_sub_i32 vcc_hi, vcc_hi, 40
    s_add_i32 s86, s87, vcc_hi
    s_sub_i32 s86, s86, vcc_lo
    s_mov_b32 s98, 0
    s_lshl_b32 s87, s87, 1
    s_add_i32 s87, s87, s86
    s_cmp_gt_i32 s87, 0
    s_cselect_b32 s87, 2, 0
    s_or_b32 s98, s98, s87
    s_lshl_b32 vcc_lo, vcc_lo, 1
    s_sub_i32 vcc_lo, vcc_lo, s86
    s_cmp_gt_i32 vcc_lo, 0
    s_cselect_b32 vcc_lo, 4, 0
    s_or_b32 s98, s98, vcc_lo
    s_lshl_b32 vcc_hi, vcc_hi, 1
    s_add_i32 vcc_hi, vcc_hi, s86
    s_cmp_gt_i32 vcc_hi, 0
    s_cselect_b32 vcc_hi, 8, 0
    s_or_b32 s98, s98, vcc_hi
    s_lshr_b32 s87, s98, 1
    s_xor_b32 s87, s87, s98
    s_and_b32 s87, s87, 7
    s_lshl_b32 s10, s98, 4
    s_or_b32 s10, s10, s87
    s_mov_b32 exec_lo, -1
    s_mov_b32 exec_hi, 0xffff
    buffer_load_dwordx4 v[24:27], v2, s[56:59], s62 offen offset:0 sc1
    buffer_load_dwordx4 v[28:31], v2, s[56:59], s62 offen offset:768 sc1
    buffer_load_dwordx4 v[32:35], v2, s[56:59], s62 offen offset:1536 sc1
    buffer_load_dwordx4 v[36:39], v2, s[56:59], s62 offen offset:2304 sc1
    buffer_load_dwordx4 v[40:43], v2, s[56:59], s62 offen offset:3072 sc1
    s_mov_b64 exec, -1
    s_lshr_b32 s86, s5, 4
    s_mul_i32 s86, s86, 2097152
    s_and_b32 s87, s5, 15
    s_lshl_b32 s87, s87, 2
    s_add_u32 s87, s87, s3
    s_mul_i32 s87, s87, 576
    s_add_u32 s86, s86, s87
    s_mul_i32 s87, s4, 36864
    s_add_u32 s86, s86, s87
    s_add_u32 s86, s86, 3604480
    s_lshl_b32 s87, s3, 11
    s_add_u32 m0, s87, 156672
    v_lshlrev_b32 v89, 6, v1
    s_mov_b64 exec, 0x1ff
    buffer_load_dword v89, s[56:59], s86 offen sc1 lds
    s_mov_b64 exec, -1
    ds_write_b128 v86, v[92:95] offset:0
    ds_write_b128 v86, v[96:99] offset:1024
    ds_write_b128 v86, v[100:103] offset:2048
    ds_write_b128 v86, v[104:107] offset:3072
    ds_write_b128 v86, v[108:111] offset:4096
    ds_write_b128 v86, v[112:115] offset:5120
    s_waitcnt lgkmcnt(0)
    s_barrier
    ds_read_b64_tr_b16 v[92:93], v87 offset:0
    ds_read_b64_tr_b16 v[94:95], v87 offset:1536
    ds_read_b64_tr_b16 v[96:97], v87 offset:32
    ds_read_b64_tr_b16 v[98:99], v87 offset:1568
    ds_read_b64_tr_b16 v[100:101], v87 offset:64
    ds_read_b64_tr_b16 v[102:103], v87 offset:1600
    ds_read_b64_tr_b16 v[104:105], v87 offset:12288
    ds_read_b64_tr_b16 v[106:107], v87 offset:13824
    ds_read_b64_tr_b16 v[108:109], v87 offset:12320
    ds_read_b64_tr_b16 v[110:111], v87 offset:13856
    ds_read_b64_tr_b16 v[112:113], v87 offset:12352
    ds_read_b64_tr_b16 v[114:115], v87 offset:13888
    s_add_u32 s79, s79, 20480
    buffer_load_dwordx4 v[164:167], v2, s[12:15], s79 offen offset:0 nt
    buffer_load_dwordx4 v[168:171], v2, s[12:15], s79 offen offset:1024 nt
    s_waitcnt vmcnt(19)
    buffer_load_dwordx4 v[172:175], v2, s[12:15], s79 offen offset:2048 nt
    s_waitcnt vmcnt(19)
    buffer_load_dwordx4 v[176:179], v2, s[12:15], s79 offen offset:3072 nt
    s_add_u32 s79, s79, 4096
    s_waitcnt vmcnt(19)
    buffer_load_dwordx4 v[180:183], v2, s[12:15], s79 offen offset:0 nt
    s_waitcnt vmcnt(19)
    buffer_load_dwordx4 v[184:187], v2, s[12:15], s79 offen offset:1024 nt
    s_waitcnt vmcnt(18)
    ds_write_b128 v86, v[116:119] offset:24576
    ds_write_b128 v86, v[120:123] offset:25600
    ds_write_b128 v86, v[124:127] offset:26624
    ds_write_b128 v86, v[128:131] offset:27648
    ds_write_b128 v86, v[132:135] offset:28672
    ds_write_b128 v86, v[136:139] offset:29696
    s_waitcnt lgkmcnt(0)
    s_barrier
    ds_read_b64_tr_b16 v[116:117], v87 offset:24576
    ds_read_b64_tr_b16 v[118:119], v87 offset:26112
    ds_read_b64_tr_b16 v[120:121], v87 offset:24608
    ds_read_b64_tr_b16 v[122:123], v87 offset:26144
    ds_read_b64_tr_b16 v[124:125], v87 offset:24640
    ds_read_b64_tr_b16 v[126:127], v87 offset:26176
    ds_read_b64_tr_b16 v[128:129], v87 offset:36864
    ds_read_b64_tr_b16 v[130:131], v87 offset:38400
    ds_read_b64_tr_b16 v[132:133], v87 offset:36896
    ds_read_b64_tr_b16 v[134:135], v87 offset:38432
    ds_read_b64_tr_b16 v[136:137], v87 offset:36928
    ds_read_b64_tr_b16 v[138:139], v87 offset:38464
    s_add_u32 s79, s79, 20480
    buffer_load_dwordx4 v[188:191], v2, s[12:15], s79 offen offset:0 nt
    buffer_load_dwordx4 v[192:195], v2, s[12:15], s79 offen offset:1024 nt
    s_waitcnt vmcnt(19)
    buffer_load_dwordx4 v[196:199], v2, s[12:15], s79 offen offset:2048 nt
    s_waitcnt vmcnt(19)
    buffer_load_dwordx4 v[200:203], v2, s[12:15], s79 offen offset:3072 nt
    s_add_u32 s79, s79, 4096
    s_waitcnt vmcnt(19)
    buffer_load_dwordx4 v[204:207], v2, s[12:15], s79 offen offset:0 nt
    s_waitcnt vmcnt(19)
    buffer_load_dwordx4 v[208:211], v2, s[12:15], s79 offen offset:1024 nt
    s_waitcnt vmcnt(13)
    s_mov_b32 exec_hi, 0xffff
    v_pk_add_f32 v[44:45], v[24:25], v[28:29]
    v_pk_add_f32 v[46:47], v[26:27], v[30:31]
    v_pk_add_f32 v[44:45], v[44:45], v[32:33]
    v_pk_add_f32 v[46:47], v[46:47], v[34:35]
    v_pk_add_f32 v[44:45], v[44:45], v[36:37]
    v_pk_add_f32 v[46:47], v[46:47], v[38:39]
    v_pk_add_f32 v[44:45], v[44:45], v[40:41]
    v_pk_add_f32 v[46:47], v[46:47], v[42:43]
    v_cvt_pk_bf16_f32 v48, v44, v45
    v_cvt_pk_bf16_f32 v49, v46, v47
    ds_write_b64 v14, v[48:49]
    s_mov_b64 exec, -1
    ds_read_b128 v[32:35], v5 offset:0
    ds_read_b128 v[36:39], v5 offset:128
    ds_read_b128 v[40:43], v5 offset:256
    ds_read_b128 v[44:47], v6 offset:0
    ds_read_b128 v[48:51], v6 offset:128
    ds_read_b128 v[52:55], v6 offset:256
    s_branch m0_QK
m0_stream2:
    ds_write_b128 v86, v[140:143] offset:0
    ds_write_b128 v86, v[144:147] offset:1024
    ds_write_b128 v86, v[148:151] offset:2048
    ds_write_b128 v86, v[152:155] offset:3072
    ds_write_b128 v86, v[156:159] offset:4096
    ds_write_b128 v86, v[160:163] offset:5120
    s_waitcnt lgkmcnt(0)
    s_barrier
    ds_read_b64_tr_b16 v[140:141], v87 offset:0
    ds_read_b64_tr_b16 v[142:143], v87 offset:1536
    ds_read_b64_tr_b16 v[144:145], v87 offset:32
    ds_read_b64_tr_b16 v[146:147], v87 offset:1568
    ds_read_b64_tr_b16 v[148:149], v87 offset:64
    ds_read_b64_tr_b16 v[150:151], v87 offset:1600
    ds_read_b64_tr_b16 v[152:153], v87 offset:12288
    ds_read_b64_tr_b16 v[154:155], v87 offset:13824
    ds_read_b64_tr_b16 v[156:157], v87 offset:12320
    ds_read_b64_tr_b16 v[158:159], v87 offset:13856
    ds_read_b64_tr_b16 v[160:161], v87 offset:12352
    ds_read_b64_tr_b16 v[162:163], v87 offset:13888
    s_add_u32 s79, s79, 20480
    buffer_load_dwordx4 v[212:215], v2, s[12:15], s79 offen offset:0 nt
    buffer_load_dwordx4 v[216:219], v2, s[12:15], s79 offen offset:1024 nt
    s_waitcnt vmcnt(14)
    buffer_load_dwordx4 v[220:223], v2, s[12:15], s79 offen offset:2048 nt
    s_waitcnt vmcnt(14)
    buffer_load_dwordx4 v[224:227], v2, s[12:15], s79 offen offset:3072 nt
    s_add_u32 s79, s79, 4096
    s_waitcnt vmcnt(14)
    buffer_load_dwordx4 v[228:231], v2, s[12:15], s79 offen offset:0 nt
    s_waitcnt vmcnt(14)
    buffer_load_dwordx4 v[232:235], v2, s[12:15], s79 offen offset:1024 nt
    s_waitcnt vmcnt(13)
    ds_write_b128 v86, v[164:167] offset:24576
    ds_write_b128 v86, v[168:171] offset:25600
    ds_write_b128 v86, v[172:175] offset:26624
    ds_write_b128 v86, v[176:179] offset:27648
    ds_write_b128 v86, v[180:183] offset:28672
    ds_write_b128 v86, v[184:187] offset:29696
    s_waitcnt lgkmcnt(0)
    s_barrier
    ds_read_b64_tr_b16 v[164:165], v87 offset:24576
    ds_read_b64_tr_b16 v[166:167], v87 offset:26112
    ds_read_b64_tr_b16 v[168:169], v87 offset:24608
    ds_read_b64_tr_b16 v[170:171], v87 offset:26144
    ds_read_b64_tr_b16 v[172:173], v87 offset:24640
    ds_read_b64_tr_b16 v[174:175], v87 offset:26176
    ds_read_b64_tr_b16 v[176:177], v87 offset:36864
    ds_read_b64_tr_b16 v[178:179], v87 offset:38400
    ds_read_b64_tr_b16 v[180:181], v87 offset:36896
    ds_read_b64_tr_b16 v[182:183], v87 offset:38432
    ds_read_b64_tr_b16 v[184:185], v87 offset:36928
    ds_read_b64_tr_b16 v[186:187], v87 offset:38464
    s_add_u32 s79, s79, 20480
    buffer_load_dwordx4 v[236:239], v2, s[12:15], s79 offen offset:0 nt
    buffer_load_dwordx4 v[240:243], v2, s[12:15], s79 offen offset:1024 nt
    s_waitcnt vmcnt(14)
    buffer_load_dwordx4 v[244:247], v2, s[12:15], s79 offen offset:2048 nt
    s_waitcnt vmcnt(14)
    buffer_load_dwordx4 v[248:251], v2, s[12:15], s79 offen offset:3072 nt
    s_add_u32 s79, s79, 4096
    s_waitcnt vmcnt(14)
    buffer_load_dwordx4 v[252:255], v2, s[12:15], s79 offen offset:0 nt
    s_waitcnt vmcnt(14)
    buffer_load_dwordx4 a[228:231], v2, s[12:15], s79 offen offset:1024 nt
    s_waitcnt vmcnt(13)
    ds_write_b128 v86, v[188:191] offset:0
    ds_write_b128 v86, v[192:195] offset:1024
    ds_write_b128 v86, v[196:199] offset:2048
    ds_write_b128 v86, v[200:203] offset:3072
    ds_write_b128 v86, v[204:207] offset:4096
    ds_write_b128 v86, v[208:211] offset:5120
    s_waitcnt lgkmcnt(0)
    s_barrier
    ds_read_b64_tr_b16 v[188:189], v87 offset:0
    ds_read_b64_tr_b16 v[190:191], v87 offset:1536
    ds_read_b64_tr_b16 v[192:193], v87 offset:32
    ds_read_b64_tr_b16 v[194:195], v87 offset:1568
    ds_read_b64_tr_b16 v[196:197], v87 offset:64
    ds_read_b64_tr_b16 v[198:199], v87 offset:1600
    ds_read_b64_tr_b16 v[200:201], v87 offset:12288
    ds_read_b64_tr_b16 v[202:203], v87 offset:13824
    ds_read_b64_tr_b16 v[204:205], v87 offset:12320
    ds_read_b64_tr_b16 v[206:207], v87 offset:13856
    ds_read_b64_tr_b16 v[208:209], v87 offset:12352
    ds_read_b64_tr_b16 v[210:211], v87 offset:13888
    s_add_u32 s79, s79, 20480
    buffer_load_dwordx4 a[232:235], v2, s[12:15], s79 offen offset:0 nt
    buffer_load_dwordx4 a[236:239], v2, s[12:15], s79 offen offset:1024 nt
    s_waitcnt vmcnt(13)
    buffer_load_dwordx4 a[240:243], v2, s[12:15], s79 offen offset:2048 nt
    s_waitcnt vmcnt(13)
    buffer_load_dwordx4 a[244:247], v2, s[12:15], s79 offen offset:3072 nt
    s_add_u32 s79, s79, 4096
    s_waitcnt vmcnt(13)
    buffer_load_dwordx4 a[248:251], v2, s[12:15], s79 offen offset:0 nt
    s_waitcnt vmcnt(13)
    buffer_load_dwordx4 a[252:255], v2, s[12:15], s79 offen offset:1024 nt
    v_mov_b32 v40, -1
    v_mov_b32 v41, -1
    v_mov_b32 v42, -1
    v_mov_b32 v43, -1
    s_lshr_b32 s86, s5, 4
    s_mul_i32 s86, s86, 294912
    s_and_b32 s87, s5, 15
    s_lshl_b32 s87, s87, 2
    s_add_u32 s87, s87, s3
    s_mul_i32 s87, s87, 576
    s_add_u32 s86, s86, s87
    s_mul_i32 s87, s4, 36864
    s_add_u32 s86, s86, s87
    s_add_u32 s86, s86, 5701632
    s_mov_b32 exec_hi, 0xf
    buffer_store_dwordx4 v[40:43], v2, s[56:59], s86 offen
    s_and_b32 s87, s5, 15
    s_lshl_b32 s87, s87, 2
    s_add_u32 s87, s87, s3
    s_mul_i32 s87, s87, 96
    s_lshr_b32 s98, s5, 4
    s_lshl_b32 s98, s98, 13
    s_add_u32 s87, s87, s98
    s_mul_i32 s98, s4, 16640
    s_add_u32 s87, s87, s98
    s_add_u32 s87, s87, 4194304
    s_mov_b64 exec, 0x3f
    buffer_store_dwordx4 v[40:43], v2, s[56:59], s87 offen sc1
    s_mov_b64 exec, -1
    buffer_load_dwordx4 v[36:39], v13, s[56:59], s64 offen sc1
    s_waitcnt vmcnt(15)
    ds_write_b128 v86, v[212:215] offset:24576
    ds_write_b128 v86, v[216:219] offset:25600
    ds_write_b128 v86, v[220:223] offset:26624
    ds_write_b128 v86, v[224:227] offset:27648
    ds_write_b128 v86, v[228:231] offset:28672
    ds_write_b128 v86, v[232:235] offset:29696
    s_waitcnt lgkmcnt(0)
    s_barrier
    ds_read_b64_tr_b16 v[212:213], v87 offset:24576
    ds_read_b64_tr_b16 v[214:215], v87 offset:26112
    ds_read_b64_tr_b16 v[216:217], v87 offset:24608
    ds_read_b64_tr_b16 v[218:219], v87 offset:26144
    ds_read_b64_tr_b16 v[220:221], v87 offset:24640
    ds_read_b64_tr_b16 v[222:223], v87 offset:26176
    ds_read_b64_tr_b16 v[224:225], v87 offset:36864
    ds_read_b64_tr_b16 v[226:227], v87 offset:38400
    ds_read_b64_tr_b16 v[228:229], v87 offset:36896
    ds_read_b64_tr_b16 v[230:231], v87 offset:38432
    ds_read_b64_tr_b16 v[232:233], v87 offset:36928
    ds_read_b64_tr_b16 v[234:235], v87 offset:38464
    v_lshrrev_b32 v91, 4, v1
    v_mul_u32_u24 v90, 1280, v91
    v_lshlrev_b32 v91, 5, v91
    v_xor_b32 v91, v91, v2
    v_and_b32 v91, 0xf0, v91
    v_add_u32 v90, v90, v91
    v_xor_b32 v91, 128, v90
    s_mul_i32 s98, s3, 40896
    s_add_u32 s98, s98, s80
    s_lshl_b32 vcc_lo, s3, 13
    s_add_u32 m0, vcc_lo, 49152
    s_nop 0
    buffer_load_dwordx4 v90, s[20:23], s98 offen  lds
    s_add_u32 s98, s98, 5120
    s_add_u32 m0, vcc_lo, 50176
    s_nop 0
    buffer_load_dwordx4 v90, s[20:23], s98 offen  lds
    s_add_u32 s98, s98, 5120
    s_add_u32 m0, vcc_lo, 51200
    s_waitcnt vmcnt(16)
    buffer_load_dwordx4 v91, s[20:23], s98 offen  lds
    s_add_u32 s98, s98, 5120
    s_add_u32 m0, vcc_lo, 52224
    s_waitcnt vmcnt(16)
    buffer_load_dwordx4 v91, s[20:23], s98 offen  lds
    s_add_u32 s98, s98, 5120
    s_add_u32 m0, vcc_lo, 53248
    s_waitcnt vmcnt(16)
    buffer_load_dwordx4 v90, s[20:23], s98 offen  lds
    s_add_u32 s98, s98, 5120
    s_add_u32 m0, vcc_lo, 54272
    s_waitcnt vmcnt(16)
    buffer_load_dwordx4 v90, s[20:23], s98 offen  lds
    s_add_u32 s98, s98, 5120
    s_add_u32 m0, vcc_lo, 55296
    s_waitcnt vmcnt(16)
    buffer_load_dwordx4 v91, s[20:23], s98 offen  lds
    s_add_u32 s98, s98, 5120
    s_add_u32 m0, vcc_lo, 56320
    s_waitcnt vmcnt(16)
    buffer_load_dwordx4 v91, s[20:23], s98 offen  lds
    ds_write_b128 v86, v[236:239] offset:0
    ds_write_b128 v86, v[240:243] offset:1024
    ds_write_b128 v86, v[244:247] offset:2048
    ds_write_b128 v86, v[248:251] offset:3072
    ds_write_b128 v86, v[252:255] offset:4096
    ds_write_b128 v86, a[228:231] offset:5120
    s_waitcnt lgkmcnt(0)
    s_barrier
    ds_read_b64_tr_b16 v[236:237], v87 offset:0
    ds_read_b64_tr_b16 v[238:239], v87 offset:1536
    ds_read_b64_tr_b16 v[240:241], v87 offset:32
    ds_read_b64_tr_b16 v[242:243], v87 offset:1568
    ds_read_b64_tr_b16 v[244:245], v87 offset:64
    ds_read_b64_tr_b16 v[246:247], v87 offset:1600
    ds_read_b64_tr_b16 v[248:249], v87 offset:12288
    ds_read_b64_tr_b16 v[250:251], v87 offset:13824
    ds_read_b64_tr_b16 v[252:253], v87 offset:12320
    ds_read_b64_tr_b16 v[254:255], v87 offset:13856
    ds_read_b64_tr_b16 a[228:229], v87 offset:12352
    ds_read_b64_tr_b16 a[230:231], v87 offset:13888
    v_bfe_u32 v54, v1, 2, 2
    v_lshrrev_b32 v55, 5, v1
    v_lshl_add_u32 v50, v54, 2, v55
    v_lshl_add_u32 v51, v54, 1, v55
    v_mul_u32_u24 v50, 12288, v50
    v_mul_u32_u24 v51, 12288, v51
    v_and_b32 v54, 16, v1
    v_and_b32 v55, 3, v1
    v_lshlrev_b32 v54, 2, v54
    v_lshl_add_u32 v54, v55, 4, v54
    v_add_u32 v50, v50, v54
    v_add_u32 v51, v51, v54
    s_add_u32 s86, s84, 24576
    s_add_u32 s87, s84, 196608
    s_waitcnt vmcnt(16)
    buffer_load_dwordx4 a[192:195], v50, s[32:35], s84 offen offset:0 nt
    s_waitcnt vmcnt(16)
    buffer_load_dwordx4 a[196:199], v50, s[32:35], s84 offen offset:128 nt
    s_waitcnt vmcnt(16)
    buffer_load_dwordx4 a[200:203], v50, s[32:35], s84 offen offset:256 nt
    s_waitcnt vmcnt(16)
    buffer_load_dwordx4 a[204:207], v50, s[32:35], s86 offen offset:0 nt
    s_waitcnt vmcnt(16)
    buffer_load_dwordx4 a[208:211], v50, s[32:35], s86 offen offset:128 nt
    s_waitcnt vmcnt(16)
    buffer_load_dwordx4 a[212:215], v50, s[32:35], s86 offen offset:256 nt
    s_waitcnt vmcnt(13)
    buffer_load_dwordx4 a[216:219], v51, s[32:35], s87 offen offset:0 nt
    s_waitcnt vmcnt(13)
    buffer_load_dwordx4 a[220:223], v51, s[32:35], s87 offen offset:128 nt
    s_waitcnt vmcnt(13)
    buffer_load_dwordx4 a[224:227], v51, s[32:35], s87 offen offset:256 nt
    ds_write_b128 v86, a[232:235] offset:24576
    ds_write_b128 v86, a[236:239] offset:25600
    ds_write_b128 v86, a[240:243] offset:26624
    ds_write_b128 v86, a[244:247] offset:27648
    ds_write_b128 v86, a[248:251] offset:28672
    ds_write_b128 v86, a[252:255] offset:29696
    s_waitcnt lgkmcnt(0)
    s_barrier
    ds_read_b64_tr_b16 a[232:233], v87 offset:24576
    ds_read_b64_tr_b16 a[234:235], v87 offset:26112
    ds_read_b64_tr_b16 a[236:237], v87 offset:24608
    ds_read_b64_tr_b16 a[238:239], v87 offset:26144
    ds_read_b64_tr_b16 a[240:241], v87 offset:24640
    ds_read_b64_tr_b16 a[242:243], v87 offset:26176
    ds_read_b64_tr_b16 a[244:245], v87 offset:36864
    ds_read_b64_tr_b16 a[246:247], v87 offset:38400
    ds_read_b64_tr_b16 a[248:249], v87 offset:36896
    ds_read_b64_tr_b16 a[250:251], v87 offset:38432
    ds_read_b64_tr_b16 a[252:253], v87 offset:36928
    ds_read_b64_tr_b16 a[254:255], v87 offset:38464
    s_branch m0_PV
m0_stream3:
    v_add_u32 v50, 4294930432, v9
    s_waitcnt vmcnt(10)
    s_barrier
    v_xor_b32 v51, 32, v50
    ds_read_b64_tr_b16 v[56:57], v50 offset:0
    ds_read_b64_tr_b16 v[58:59], v50 offset:1024
    ds_read_b64_tr_b16 v[60:61], v51 offset:0
    ds_read_b64_tr_b16 v[62:63], v51 offset:1024
    ds_read_b64_tr_b16 v[64:65], v50 offset:8192
    ds_read_b64_tr_b16 v[66:67], v50 offset:9216
    ds_read_b64_tr_b16 v[68:69], v51 offset:8192
    ds_read_b64_tr_b16 v[70:71], v51 offset:9216
    ds_read_b64_tr_b16 v[72:73], v50 offset:16384
    ds_read_b64_tr_b16 v[74:75], v50 offset:17408
    ds_read_b64_tr_b16 v[76:77], v51 offset:16384
    ds_read_b64_tr_b16 v[78:79], v51 offset:17408
    ds_read_b64_tr_b16 v[80:81], v50 offset:24576
    ds_read_b64_tr_b16 v[82:83], v50 offset:25600
    ds_read_b64_tr_b16 v[84:85], v51 offset:24576
    ds_read_b64_tr_b16 v[86:87], v51 offset:25600
    v_and_b32 v49, 7, v1
    v_lshlrev_b32 v48, 3, v16
    v_lshl_add_u32 v48, v49, 4, v48
    s_lshl_b32 s87, s4, 5
    s_add_u32 s86, s5, s87
    s_mul_i32 s79, s86, 24576
    s_mul_i32 s86, s3, 384
    s_add_u32 s79, s79, s86
    s_waitcnt lgkmcnt(0)
    v_lshrrev_b32 v55, 4, v1
    v_mul_u32_u24 v54, 12288, v55
    v_lshlrev_b32 v55, 5, v55
    v_xor_b32 v55, v55, v2
    v_and_b32 v55, 0xf0, v55
    v_add_u32 v54, v54, v55
    v_xor_b32 v55, 128, v54
    s_mul_i32 s98, s3, 393152
    s_add_u32 s98, s98, s83
    s_lshl_b32 vcc_lo, s3, 13
    s_add_u32 m0, vcc_lo, 118784
    s_nop 0
    buffer_load_dwordx4 v54, s[28:31], s98 offen nt lds
    s_add_u32 s98, s98, 49152
    s_add_u32 m0, vcc_lo, 119808
    s_nop 0
    buffer_load_dwordx4 v54, s[28:31], s98 offen nt lds
    s_add_u32 s98, s98, 49152
    s_add_u32 m0, vcc_lo, 120832
    s_nop 0
    buffer_load_dwordx4 v55, s[28:31], s98 offen nt lds
    s_add_u32 s98, s98, 49152
    s_add_u32 m0, vcc_lo, 121856
    s_nop 0
    buffer_load_dwordx4 v55, s[28:31], s98 offen nt lds
    s_add_u32 s98, s98, 49152
    s_add_u32 m0, vcc_lo, 122880
    s_nop 0
    buffer_load_dwordx4 v54, s[28:31], s98 offen nt lds
    s_add_u32 s98, s98, 49152
    s_add_u32 m0, vcc_lo, 123904
    s_waitcnt vmcnt(14)
    buffer_load_dwordx4 v54, s[28:31], s98 offen nt lds
    s_add_u32 s98, s98, 49152
    s_add_u32 m0, vcc_lo, 124928
    s_waitcnt vmcnt(14)
    buffer_load_dwordx4 v55, s[28:31], s98 offen nt lds
    s_add_u32 s98, s98, 49152
    s_add_u32 m0, vcc_lo, 125952
    s_waitcnt vmcnt(14)
    buffer_load_dwordx4 v55, s[28:31], s98 offen nt lds
    s_mov_b32 exec_lo, 0x00ff00ff
    s_mov_b32 exec_hi, 0x00ff00ff
    buffer_load_dwordx4 v[24:27], v48, s[56:59], s66 offen offset:0 sc1
    buffer_load_dwordx4 v[28:31], v48, s[56:59], s66 offen offset:512 sc1
    buffer_load_dwordx4 v[32:35], v48, s[56:59], s66 offen offset:1024 sc1
    buffer_load_dwordx4 v[36:39], v48, s[56:59], s66 offen offset:1536 sc1
    s_mov_b64 exec, -1
    s_barrier
    v_lshrrev_b32 v54, 3, v1
    v_mul_u32_u24 v54, 1536, v54
    v_xor_b32 v55, v2, v16
    v_and_b32 v55, 0x70, v55
    v_add_u32 v54, v54, v55
    v_xor_b32 v55, 64, v54
    s_mul_i32 s86, s3, 12288
    s_add_u32 m0, s86, 0
    s_add_u32 s87, s79, 0
    s_waitcnt vmcnt(18)
    buffer_load_dwordx4 v54, s[24:27], s87 offen  lds
    s_add_u32 m0, s86, 1024
    s_add_u32 s87, s79, 12288
    s_waitcnt vmcnt(18)
    buffer_load_dwordx4 v55, s[24:27], s87 offen  lds
    s_add_u32 m0, s86, 2048
    s_add_u32 s87, s79, 128
    s_waitcnt vmcnt(18)
    buffer_load_dwordx4 v54, s[24:27], s87 offen  lds
    s_add_u32 m0, s86, 3072
    s_add_u32 s87, s79, 12416
    s_waitcnt vmcnt(18)
    buffer_load_dwordx4 v55, s[24:27], s87 offen  lds
    s_add_u32 m0, s86, 4096
    s_add_u32 s87, s79, 256
    s_waitcnt vmcnt(18)
    buffer_load_dwordx4 v54, s[24:27], s87 offen  lds
    s_add_u32 m0, s86, 5120
    s_add_u32 s87, s79, 12544
    s_waitcnt vmcnt(18)
    buffer_load_dwordx4 v55, s[24:27], s87 offen  lds
    s_waitcnt vmcnt(6)
m0_O0_go:
    v_mfma_f32_16x16x32_bf16 v[40:43], v[24:27], v[56:59], 0
    v_mfma_f32_16x16x32_bf16 v[44:47], v[24:27], v[60:63], 0
    v_mfma_f32_16x16x32_bf16 v[40:43], v[28:31], v[64:67], v[40:43]
    v_mfma_f32_16x16x32_bf16 v[44:47], v[28:31], v[68:71], v[44:47]
    v_mfma_f32_16x16x32_bf16 v[40:43], v[32:35], v[72:75], v[40:43]
    v_mfma_f32_16x16x32_bf16 v[44:47], v[32:35], v[76:79], v[44:47]
    v_mfma_f32_16x16x32_bf16 v[40:43], v[36:39], v[80:83], v[40:43]
    v_mfma_f32_16x16x32_bf16 v[44:47], v[36:39], v[84:87], v[44:47]
    s_nop 6
    v_pk_add_f32 v[40:41], v[40:41], v[42:43]
    v_pk_add_f32 v[44:45], v[44:45], v[46:47]
    v_add_f32 v40, v40, v41
    v_add_f32 v44, v44, v45
    s_nop 1
    v_permlane16_swap_b32 v40, v44
    v_add_f32 v40, v40, v44
    s_mov_b32 exec_hi, 0
    v_cmp_u_f32 vcc, v40, v40
    s_xor_b32 s86, s67, 8192
    s_cbranch_vccnz m0_O0_rt
m0_O0_ok:
    buffer_store_dword v40, v17, s[56:59], s67 offen sc1
    buffer_store_dword v40, v17, s[56:59], s86 offen sc1
    s_mov_b64 exec, -1
    s_barrier
    v_mov_b32 v48, -1
    v_mov_b32 v49, -1
    v_mov_b32 v50, -1
    v_mov_b32 v51, -1
    s_lshl_b32 s87, s4, 5
    s_add_u32 s87, s87, s5
    s_lshl_b32 s87, s87, 2
    s_add_u32 s87, s87, s3
    s_lshl_b32 s87, s87, 10
    s_add_u32 s98, s87, 4653056
    buffer_store_dwordx4 v[48:51], v2, s[56:59], s98 offen sc1
    s_lshl_b32 s86, s5, 2
    s_add_u32 s86, s86, s3
    s_mul_i32 s86, s86, 288
    s_mul_i32 s87, s4, 36864
    s_add_u32 s86, s86, s87
    s_add_u32 s86, s86, 7798784
    s_mov_b64 exec, 0x3ffff
    buffer_store_dwordx4 v[48:51], v2, s[56:59], s86 offen
    s_mov_b64 exec, -1
    v_and_b32 v52, 8, v1
    v_mul_u32_u24 v52, 1008, v52
    v_add_u32 v52, v52, v2
    s_mov_b64 exec, 0xffff
    s_andn2_b32 s86, s67, 8192
    s_add_u32 s98, s86, 2097152
    buffer_store_dwordx4 v[48:51], v52, s[56:59], s98 offen sc1
    s_add_u32 s98, s86, 4194304
    buffer_store_dwordx4 v[48:51], v52, s[56:59], s98 offen sc1
    s_mov_b64 exec, -1
    s_lshr_b32 s86, s5, 4
    s_mul_i32 s86, s86, 2097152
    s_and_b32 s87, s5, 15
    s_lshl_b32 s87, s87, 2
    s_add_u32 s87, s87, s3
    s_mul_i32 s87, s87, 576
    s_add_u32 s86, s86, s87
    s_mul_i32 s87, s4, 36864
    s_add_u32 s86, s86, s87
    s_add_u32 s86, s86, 3604480
    s_lshl_b32 s87, s3, 11
    s_add_u32 m0, s87, 156672
    v_lshlrev_b32 v89, 6, v1
    s_mov_b64 exec, 0x1ff
    buffer_load_dword v89, s[56:59], s86 offen sc1 lds
    s_mov_b64 exec, -1
    s_lshr_b32 s86, s5, 4
    s_mul_i32 s86, s86, 4194304
    s_and_b32 s87, s5, 15
    s_lshl_b32 s87, s87, 2
    s_add_u32 s87, s87, s3
    s_mul_i32 s87, s87, 576
    s_add_u32 s86, s86, s87
    s_mul_i32 s87, s4, 36864
    s_add_u32 s86, s86, s87
    s_add_u32 s86, s86, 5996544
    s_lshl_b32 s87, s3, 11
    s_add_u32 m0, s87, 156672
    v_lshlrev_b32 v89, 6, v1
    s_mov_b64 exec, 0x1ff
    buffer_load_dword v89, s[56:59], s86 offen sc1 lds
    s_mov_b64 exec, -1
    s_lshr_b32 s86, s5, 3
    s_lshl_b32 s87, s4, 2
    s_add_u32 s86, s86, s87
    s_mul_i32 s98, s86, 384
    s_and_b32 s87, s5, 7
    s_lshl_b32 s87, s87, 2
    s_add_u32 s87, s87, s3
    s_mul_i32 s87, s87, 294912
    s_add_u32 s98, s98, s87
    s_mul_i32 s86, s3, 9216
    v_add_u32 v50, 0, v1
    v_mul_u32_u24 v53, 2731, v50
    v_lshrrev_b32 v53, 16, v53
    v_mul_u32_u24 v53, 11904, v53
    v_lshl_add_u32 v50, v50, 4, v53
    v_add_u32 v51, 64, v1
    v_mul_u32_u24 v53, 2731, v51
    v_lshrrev_b32 v53, 16, v53
    v_mul_u32_u24 v53, 11904, v53
    v_lshl_add_u32 v51, v51, 4, v53
    v_add_u32 v52, 128, v1
    v_mul_u32_u24 v53, 2731, v52
    v_lshrrev_b32 v53, 16, v53
    v_mul_u32_u24 v53, 11904, v53
    v_lshl_add_u32 v52, v52, 4, v53
    s_add_u32 m0, s86, 49152
    s_nop 0
    buffer_load_dwordx4 v50, s[36:39], s98 offen nt lds
    s_add_u32 m0, s86, 50176
    s_nop 0
    buffer_load_dwordx4 v51, s[36:39], s98 offen nt lds
    s_add_u32 m0, s86, 51200
    s_nop 0
    buffer_load_dwordx4 v52, s[36:39], s98 offen nt lds
    s_add_u32 s98, s98, 98304
    s_add_u32 m0, s86, 52224
    s_nop 0
    buffer_load_dwordx4 v50, s[36:39], s98 offen nt lds
    s_add_u32 m0, s86, 53248
    s_nop 0
    buffer_load_dwordx4 v51, s[36:39], s98 offen nt lds
    s_add_u32 m0, s86, 54272
    s_nop 0
    buffer_load_dwordx4 v52, s[36:39], s98 offen nt lds
    s_add_u32 s98, s98, 98304
    s_add_u32 m0, s86, 55296
    s_nop 0
    buffer_load_dwordx4 v50, s[36:39], s98 offen nt lds
    s_add_u32 m0, s86, 56320
    s_nop 0
    buffer_load_dwordx4 v51, s[36:39], s98 offen nt lds
    s_add_u32 m0, s86, 57344
    s_waitcnt vmcnt(15)
    buffer_load_dwordx4 v52, s[36:39], s98 offen nt lds
    v_add_u32 v52, 0, v1
    v_mul_u32_u24 v55, 10923, v52
    v_lshrrev_b32 v55, 16, v55
    v_mul_u32_u24 v55, 1440, v55
    v_lshl_add_u32 v52, v52, 4, v55
    v_add_u32 v53, 64, v1
    v_mul_u32_u24 v55, 10923, v53
    v_lshrrev_b32 v55, 16, v55
    v_mul_u32_u24 v55, 1440, v55
    v_lshl_add_u32 v53, v53, 4, v55
    v_add_u32 v54, 128, v1
    v_mul_u32_u24 v55, 10923, v54
    v_lshrrev_b32 v55, 16, v55
    v_mul_u32_u24 v55, 1440, v55
    v_lshl_add_u32 v54, v54, 4, v55
    s_mul_i32 s86, s3, 12288
    s_add_u32 s87, s77, 49152
    s_add_u32 m0, s86, 6144
    s_waitcnt vmcnt(15)
    buffer_load_dwordx4 v52, s[24:27], s77 offen lds
    s_add_u32 m0, s86, 7168
    s_waitcnt vmcnt(15)
    buffer_load_dwordx4 v53, s[24:27], s77 offen lds
    s_add_u32 m0, s86, 8192
    s_waitcnt vmcnt(15)
    buffer_load_dwordx4 v54, s[24:27], s77 offen lds
    s_add_u32 m0, s86, 9216
    s_waitcnt vmcnt(15)
    buffer_load_dwordx4 v52, s[24:27], s87 offen lds
    s_add_u32 m0, s86, 10240
    s_waitcnt vmcnt(15)
    buffer_load_dwordx4 v53, s[24:27], s87 offen lds
    s_add_u32 m0, s86, 11264
    s_waitcnt vmcnt(13)
    buffer_load_dwordx4 v54, s[24:27], s87 offen lds
    s_mov_b32 s83, s80
    s_mov_b32 s84, s79
    s_and_b32 s86, s3, 1
    s_lshl_b32 s79, s86, 19
    s_lshl_b32 s86, s4, 15
    s_add_u32 s79, s79, s86
    s_lshr_b32 s86, s5, 4
    s_lshl_b32 s86, s86, 14
    s_add_u32 s79, s79, s86
    s_lshr_b32 s86, s3, 1
    s_lshl_b32 s86, s86, 13
    s_add_u32 s79, s79, s86
    s_and_b32 s86, s5, 15
    s_lshl_b32 s86, s86, 9
    s_add_u32 s79, s79, s86
    s_add_u32 s79, s79, 2555904
    s_and_b32 s86, s4, 3
    s_lshl_b32 s80, s86, 18
    s_lshr_b32 s86, s4, 2
    s_lshl_b32 s86, s86, 13
    s_add_u32 s80, s80, s86
    s_and_b32 s86, s5, 4
    s_lshl_b32 s86, s86, 12
    s_add_u32 s80, s80, s86
    s_and_b32 s86, s5, 3
    s_lshl_b32 s86, s86, 11
    s_add_u32 s80, s80, s86
    s_lshl_b32 s86, s3, 9
    s_add_u32 s80, s80, s86
    s_lshr_b32 s86, s5, 3
    s_lshl_b32 s86, s86, 7
    s_add_u32 s80, s80, s86
    s_add_u32 s80, s80, 2555904
    s_lshr_b32 s86, s4, 2
    s_xor_b32 s86, s86, 1
    s_lshl_b32 s86, s86, 13
    s_xor_b32 s67, s67, s86
    s_xor_b32 s73, s73, s86
    s_branch m0_E
m0_bar_slow:
    s_cmp_eq_u64 s[100:101], 0
    s_cbranch_scc1 m0_fail
    s_sub_u32 s60, s60, 1
    s_cbranch_scc1 m0_bar_to
    s_sleep 8
    s_mov_b32 s86, 524288
    buffer_load_dword v88, v36, s[56:59], s86 offen sc1
    s_add_u32 s86, s86, 2048
    buffer_load_dword v89, v36, s[56:59], s86 offen sc1
    s_add_u32 s86, s86, 2048
    buffer_load_dword v90, v36, s[56:59], s86 offen sc1
    s_add_u32 s86, s86, 2048
    buffer_load_dword v91, v36, s[56:59], s86 offen sc1
    s_waitcnt vmcnt(0)
    s_branch m0_bar_chk
m0_bar_to:
    s_mov_b32 s60, 0
    s_branch m0_bar_ok
m0_go_slow:
    s_sub_u32 s60, s60, 1
    s_cbranch_scc1 m0_go_to
    s_sleep 8
    buffer_load_dwordx4 v[24:27], v2, s[52:55], 0 offen offset:128 sc1
    s_waitcnt vmcnt(0)
    s_branch m0_go_chk
m0_go_to:
    s_mov_b32 s60, 0
    s_branch m0_go_ok
m0_fail:
    s_mov_b64 exec, -1
    s_waitcnt vmcnt(0) lgkmcnt(0)
    s_barrier
    s_mov_b32 s18, 7864320
    s_branch m1_start
m0_layer:
    s_and_b32 s86, s7, 1
    s_cselect_b32 s62, s1, s85
    s_lshl_b32 s86, s86, 15
    v_add_u32 v48, s86, v9
    v_xor_b32 v49, 32, v48
    ds_read_b64_tr_b16 v[56:57], v48 offset:0
    ds_read_b64_tr_b16 v[58:59], v48 offset:1024
    ds_read_b64_tr_b16 v[60:61], v49 offset:0
    ds_read_b64_tr_b16 v[62:63], v49 offset:1024
    ds_read_b64_tr_b16 v[64:65], v48 offset:8192
    ds_read_b64_tr_b16 v[66:67], v48 offset:9216
    ds_read_b64_tr_b16 v[68:69], v49 offset:8192
    ds_read_b64_tr_b16 v[70:71], v49 offset:9216
    ds_read_b64_tr_b16 v[72:73], v48 offset:16384
    ds_read_b64_tr_b16 v[74:75], v48 offset:17408
    ds_read_b64_tr_b16 v[76:77], v49 offset:16384
    ds_read_b64_tr_b16 v[78:79], v49 offset:17408
    ds_read_b64_tr_b16 v[80:81], v48 offset:24576
    ds_read_b64_tr_b16 v[82:83], v48 offset:25600
    ds_read_b64_tr_b16 v[84:85], v49 offset:24576
    ds_read_b64_tr_b16 v[86:87], v49 offset:25600
    v_mov_b32 v52, 0x3f803f80
    v_cmp_eq_u32 vcc, 1, v23
    s_nop 1
    v_cndmask_b32 v24, 0, v52, vcc
    v_mov_b32 v25, v24
    v_mov_b32 v26, v24
    v_mov_b32 v27, v24
    v_mov_b32 v28, v24
    v_mov_b32 v29, v24
    v_mov_b32 v30, v24
    v_mov_b32 v31, v24
    v_mov_b32 v32, v24
    v_mov_b32 v33, v24
    v_mov_b32 v34, v24
    v_mov_b32 v35, v24
    v_mov_b32 v36, v24
    v_mov_b32 v37, v24
    v_mov_b32 v38, v24
    v_mov_b32 v39, v24
    v_mov_b32 v40, 0
    v_mov_b32 v41, 0
    v_mov_b32 v42, 0
    v_mov_b32 v43, 0
    s_mov_b64 exec, 0x3ff
    buffer_load_dwordx4 v[40:43], v2, s[56:59], s72 offen sc1
    s_mov_b64 exec, s[88:89]
    buffer_load_dwordx4 v[24:27], v16, s[56:59], s70 offen offset:0 sc1
    buffer_load_dwordx4 v[28:31], v16, s[56:59], s70 offen offset:64 sc1
    buffer_load_dwordx4 v[32:35], v16, s[56:59], s70 offen offset:128 sc1
    buffer_load_dwordx4 v[36:39], v16, s[56:59], s70 offen offset:192 sc1
    s_mov_b64 exec, -1
    s_waitcnt lgkmcnt(0)
m0_P_go:
    s_mov_b32 s86, 0x3727c5ac
    s_waitcnt vmcnt(4)
    v_add_f32 v52, v40, v42
    v_add_f32 v53, v41, v43
    v_cmp_u_f32 vcc, v52, v53
    s_cbranch_vccnz m0_P_rq
m0_P_rqo:
    s_waitcnt vmcnt(3)
    v_mfma_f32_16x16x32_bf16 v[44:47], v[24:27], v[56:59], 0
    v_mfma_f32_16x16x32_bf16 v[48:51], v[24:27], v[60:63], 0
    v_add_f32_dpp v52, v52, v52 row_ror:8 row_mask:0xf bank_mask:0xf
    v_add_f32_dpp v53, v53, v53 row_ror:8 row_mask:0xf bank_mask:0xf
    s_waitcnt vmcnt(2)
    v_mfma_f32_16x16x32_bf16 v[44:47], v[28:31], v[64:67], v[44:47]
    v_add_f32_dpp v52, v52, v52 row_ror:4 row_mask:0xf bank_mask:0xf
    v_add_f32_dpp v53, v53, v53 row_ror:4 row_mask:0xf bank_mask:0xf
    v_mfma_f32_16x16x32_bf16 v[48:51], v[28:31], v[68:71], v[48:51]
    v_add_f32_dpp v52, v52, v52 row_ror:2 row_mask:0xf bank_mask:0xf
    v_add_f32_dpp v53, v53, v53 row_ror:2 row_mask:0xf bank_mask:0xf
    s_waitcnt vmcnt(1)
    v_mfma_f32_16x16x32_bf16 v[44:47], v[32:35], v[72:75], v[44:47]
    v_add_f32_dpp v52, v52, v52 row_ror:1 row_mask:0xf bank_mask:0xf
    v_add_f32_dpp v53, v53, v53 row_ror:1 row_mask:0xf bank_mask:0xf
    v_mfma_f32_16x16x32_bf16 v[48:51], v[32:35], v[76:79], v[48:51]
    v_mul_f32 v52, 0x3acccccd, v52
    v_mul_f32 v53, 0x3acccccd, v53
    s_waitcnt vmcnt(0)
    v_mfma_f32_16x16x32_bf16 v[44:47], v[36:39], v[80:83], v[44:47]
    v_fma_f32 v53, -v52, v52, v53
    v_add_f32 v53, s86, abs(v53)
    v_mfma_f32_16x16x32_bf16 v[48:51], v[36:39], v[84:87], v[48:51]
    v_rsq_f32 v53, v53
    s_nop 0
    v_mul_f32 v52, v52, v53
    s_nop 1
    v_mul_f32 v54, v44, v53
    s_nop 1
    v_mul_f32 v55, v48, v53
    v_fma_f32 v54, -v52, v45, v54
    v_fma_f32 v55, -v52, v49, v55
    s_mov_b64 exec, 0xffff
    v_cmp_u_f32 vcc, v54, v55
    s_cbranch_vccnz m0_P_rt
m0_P_ok:
    buffer_store_dword v54, v17, s[56:59], s61 offen
    buffer_store_dword v55, v17, s[56:59], s61 offen offset:64
    s_mov_b64 exec, -1
    s_barrier
    s_sleep 2
m0_Q_try:
    s_mov_b32 exec_lo, -1
    s_mov_b32 exec_hi, 0xffff
    buffer_load_dwordx4 v[24:27], v2, s[56:59], s62 offen offset:0 sc1
    buffer_load_dwordx4 v[28:31], v2, s[56:59], s62 offen offset:768 sc1
    buffer_load_dwordx4 v[32:35], v2, s[56:59], s62 offen offset:1536 sc1
    buffer_load_dwordx4 v[36:39], v2, s[56:59], s62 offen offset:2304 sc1
    buffer_load_dwordx4 v[40:43], v2, s[56:59], s62 offen offset:3072 sc1
    s_waitcnt vmcnt(3)
    v_pk_add_f32 v[44:45], v[24:25], v[28:29]
    v_pk_add_f32 v[46:47], v[26:27], v[30:31]
    s_waitcnt vmcnt(2)
    v_pk_add_f32 v[44:45], v[44:45], v[32:33]
    v_pk_add_f32 v[46:47], v[46:47], v[34:35]
    s_waitcnt vmcnt(1)
    v_pk_add_f32 v[44:45], v[44:45], v[36:37]
    v_pk_add_f32 v[46:47], v[46:47], v[38:39]
    s_waitcnt vmcnt(0)
    v_pk_add_f32 v[44:45], v[44:45], v[40:41]
    v_pk_add_f32 v[46:47], v[46:47], v[42:43]
    v_cvt_pk_bf16_f32 v48, v44, v45
    v_cvt_pk_bf16_f32 v49, v46, v47
    ds_write_b64 v14, v[48:49]
    v_add_f32 v50, v44, v45
    v_add_f32 v51, v46, v47
    v_cmp_u_f32 vcc, v50, v51
    s_cbranch_vccnz m0_Q_rt
m0_Q_ok:
    s_mov_b64 exec, -1
    ds_read_b128 v[32:35], v5 offset:0
    ds_read_b128 v[36:39], v5 offset:128
    ds_read_b128 v[40:43], v5 offset:256
    ds_read_b128 v[44:47], v6 offset:0
    ds_read_b128 v[48:51], v6 offset:128
    ds_read_b128 v[52:55], v6 offset:256
    s_bitcmp1_b32 s7, 0
    s_cbranch_scc1 m0_layerB
    buffer_store_dwordx4 v[88:91], v2, s[56:59], s14 offen sc1
    s_mov_b32 exec_hi, 0xf
    buffer_store_dwordx4 v[88:91], v2, s[56:59], s18 offen
    s_mov_b64 exec, 0xff
    buffer_store_dwordx4 v[88:91], v2, s[56:59], s30 offen sc1
    buffer_store_dwordx4 v[88:91], v2, s[56:59], s38 offen sc1
    s_mov_b64 exec, 0x3f
    buffer_store_dwordx4 v[88:91], v2, s[56:59], s34 offen sc1
    s_mov_b64 exec, -1
m0_QK:
    s_waitcnt lgkmcnt(5)
    v_mfma_f32_16x16x32_bf16 v[56:59], a[0:3], v[32:35], 0
    s_waitcnt lgkmcnt(4)
    v_mfma_f32_16x16x32_bf16 v[56:59], a[4:7], v[36:39], v[56:59]
    s_waitcnt lgkmcnt(3)
    v_mfma_f32_16x16x32_bf16 v[56:59], a[8:11], v[40:43], v[56:59]
    s_waitcnt lgkmcnt(2)
    v_mfma_f32_16x16x32_bf16 v[56:59], a[12:15], v[44:47], v[56:59]
    s_waitcnt lgkmcnt(1)
    v_mfma_f32_16x16x32_bf16 v[56:59], a[16:19], v[48:51], v[56:59]
    s_waitcnt lgkmcnt(0)
    v_mfma_f32_16x16x32_bf16 v[56:59], a[20:23], v[52:55], v[56:59]
    v_mfma_f32_16x16x32_bf16 v[60:63], a[24:27], v[32:35], 0
    v_mfma_f32_16x16x32_bf16 v[60:63], a[28:31], v[36:39], v[60:63]
    v_mfma_f32_16x16x32_bf16 v[60:63], a[32:35], v[40:43], v[60:63]
    v_mfma_f32_16x16x32_bf16 v[60:63], a[36:39], v[44:47], v[60:63]
    v_mfma_f32_16x16x32_bf16 v[60:63], a[40:43], v[48:51], v[60:63]
    v_mfma_f32_16x16x32_bf16 v[60:63], a[44:47], v[52:55], v[60:63]
    s_nop 1
    v_mov_b32_dpp v72, v56 quad_perm:[0,0,0,0] row_mask:0xf bank_mask:0xf
    v_add_f32_dpp v72, v57, v72 quad_perm:[1,1,1,1] row_mask:0xf bank_mask:0xf
    v_add_f32_dpp v72, v58, v72 quad_perm:[2,2,2,2] row_mask:0xf bank_mask:0xf
    v_add_f32_dpp v72, v59, v72 quad_perm:[3,3,3,3] row_mask:0xf bank_mask:0xf
    v_mfma_f32_16x16x32_bf16 v[64:67], a[48:51], v[32:35], 0
    v_mfma_f32_16x16x32_bf16 v[64:67], a[52:55], v[36:39], v[64:67]
    v_mfma_f32_16x16x32_bf16 v[64:67], a[56:59], v[40:43], v[64:67]
    v_mfma_f32_16x16x32_bf16 v[64:67], a[60:63], v[44:47], v[64:67]
    v_mfma_f32_16x16x32_bf16 v[64:67], a[64:67], v[48:51], v[64:67]
    v_mfma_f32_16x16x32_bf16 v[64:67], a[68:71], v[52:55], v[64:67]
    v_mov_b32_dpp v73, v60 quad_perm:[0,0,0,0] row_mask:0xf bank_mask:0xf
    v_add_f32_dpp v73, v61, v73 quad_perm:[1,1,1,1] row_mask:0xf bank_mask:0xf
    v_add_f32_dpp v73, v62, v73 quad_perm:[2,2,2,2] row_mask:0xf bank_mask:0xf
    v_add_f32_dpp v73, v63, v73 quad_perm:[3,3,3,3] row_mask:0xf bank_mask:0xf
    v_mfma_f32_16x16x32_bf16 v[68:71], a[72:75], v[32:35], 0
    v_mfma_f32_16x16x32_bf16 v[68:71], a[76:79], v[36:39], v[68:71]
    v_mfma_f32_16x16x32_bf16 v[68:71], a[80:83], v[40:43], v[68:71]
    v_mfma_f32_16x16x32_bf16 v[68:71], a[84:87], v[44:47], v[68:71]
    v_mfma_f32_16x16x32_bf16 v[68:71], a[88:91], v[48:51], v[68:71]
    v_mfma_f32_16x16x32_bf16 v[68:71], a[92:95], v[52:55], v[68:71]
    v_mov_b32_dpp v74, v64 quad_perm:[0,0,0,0] row_mask:0xf bank_mask:0xf
    v_add_f32_dpp v74, v65, v74 quad_perm:[1,1,1,1] row_mask:0xf bank_mask:0xf
    v_add_f32_dpp v74, v66, v74 quad_perm:[2,2,2,2] row_mask:0xf bank_mask:0xf
    v_add_f32_dpp v74, v67, v74 quad_perm:[3,3,3,3] row_mask:0xf bank_mask:0xf
    v_mfma_f32_16x16x32_bf16 v[56:59], a[96:99], v[32:35], 0
    v_mfma_f32_16x16x32_bf16 v[56:59], a[100:103], v[36:39], v[56:59]
    v_mfma_f32_16x16x32_bf16 v[56:59], a[104:107], v[40:43], v[56:59]
    v_mfma_f32_16x16x32_bf16 v[56:59], a[108:111], v[44:47], v[56:59]
    v_mfma_f32_16x16x32_bf16 v[56:59], a[112:115], v[48:51], v[56:59]
    v_mfma_f32_16x16x32_bf16 v[56:59], a[116:119], v[52:55], v[56:59]
    v_mov_b32_dpp v75, v68 quad_perm:[0,0,0,0] row_mask:0xf bank_mask:0xf
    v_add_f32_dpp v75, v69, v75 quad_perm:[1,1,1,1] row_mask:0xf bank_mask:0xf
    v_add_f32_dpp v75, v70, v75 quad_perm:[2,2,2,2] row_mask:0xf bank_mask:0xf
    v_add_f32_dpp v75, v71, v75 quad_perm:[3,3,3,3] row_mask:0xf bank_mask:0xf
    v_mfma_f32_16x16x32_bf16 v[60:63], a[120:123], v[32:35], 0
    v_mfma_f32_16x16x32_bf16 v[60:63], a[124:127], v[36:39], v[60:63]
    v_mfma_f32_16x16x32_bf16 v[60:63], a[128:131], v[40:43], v[60:63]
    v_mfma_f32_16x16x32_bf16 v[60:63], a[132:135], v[44:47], v[60:63]
    v_mfma_f32_16x16x32_bf16 v[60:63], a[136:139], v[48:51], v[60:63]
    v_mfma_f32_16x16x32_bf16 v[60:63], a[140:143], v[52:55], v[60:63]
    v_mov_b32_dpp v76, v56 quad_perm:[0,0,0,0] row_mask:0xf bank_mask:0xf
    v_add_f32_dpp v76, v57, v76 quad_perm:[1,1,1,1] row_mask:0xf bank_mask:0xf
    v_add_f32_dpp v76, v58, v76 quad_perm:[2,2,2,2] row_mask:0xf bank_mask:0xf
    v_add_f32_dpp v76, v59, v76 quad_perm:[3,3,3,3] row_mask:0xf bank_mask:0xf
    v_mfma_f32_16x16x32_bf16 v[64:67], a[144:147], v[32:35], 0
    v_mfma_f32_16x16x32_bf16 v[64:67], a[148:151], v[36:39], v[64:67]
    v_mfma_f32_16x16x32_bf16 v[64:67], a[152:155], v[40:43], v[64:67]
    v_mfma_f32_16x16x32_bf16 v[64:67], a[156:159], v[44:47], v[64:67]
    v_mfma_f32_16x16x32_bf16 v[64:67], a[160:163], v[48:51], v[64:67]
    v_mfma_f32_16x16x32_bf16 v[64:67], a[164:167], v[52:55], v[64:67]
    v_mov_b32_dpp v77, v60 quad_perm:[0,0,0,0] row_mask:0xf bank_mask:0xf
    v_add_f32_dpp v77, v61, v77 quad_perm:[1,1,1,1] row_mask:0xf bank_mask:0xf
    v_add_f32_dpp v77, v62, v77 quad_perm:[2,2,2,2] row_mask:0xf bank_mask:0xf
    v_add_f32_dpp v77, v63, v77 quad_perm:[3,3,3,3] row_mask:0xf bank_mask:0xf
    v_mfma_f32_16x16x32_bf16 v[68:71], a[168:171], v[32:35], 0
    v_mfma_f32_16x16x32_bf16 v[68:71], a[172:175], v[36:39], v[68:71]
    v_mfma_f32_16x16x32_bf16 v[68:71], a[176:179], v[40:43], v[68:71]
    v_mfma_f32_16x16x32_bf16 v[68:71], a[180:183], v[44:47], v[68:71]
    v_mfma_f32_16x16x32_bf16 v[68:71], a[184:187], v[48:51], v[68:71]
    v_mfma_f32_16x16x32_bf16 v[68:71], a[188:191], v[52:55], v[68:71]
    v_mov_b32_dpp v78, v64 quad_perm:[0,0,0,0] row_mask:0xf bank_mask:0xf
    v_add_f32_dpp v78, v65, v78 quad_perm:[1,1,1,1] row_mask:0xf bank_mask:0xf
    v_add_f32_dpp v78, v66, v78 quad_perm:[2,2,2,2] row_mask:0xf bank_mask:0xf
    v_add_f32_dpp v78, v67, v78 quad_perm:[3,3,3,3] row_mask:0xf bank_mask:0xf
    s_nop 3
    v_mov_b32_dpp v79, v68 quad_perm:[0,0,0,0] row_mask:0xf bank_mask:0xf
    v_add_f32_dpp v79, v69, v79 quad_perm:[1,1,1,1] row_mask:0xf bank_mask:0xf
    v_add_f32_dpp v79, v70, v79 quad_perm:[2,2,2,2] row_mask:0xf bank_mask:0xf
    v_add_f32_dpp v79, v71, v79 quad_perm:[3,3,3,3] row_mask:0xf bank_mask:0xf
    v_max3_f32 v80, v72, v73, v74
    v_max3_f32 v80, v80, v75, v76
    v_max3_f32 v80, v80, v77, v78
    v_max_f32 v80, v80, v79
    s_nop 1
    v_max_f32_dpp v80, v80, v80 row_ror:4 row_mask:0xf bank_mask:0xf
    s_nop 1
    v_max_f32_dpp v80, v80, v80 row_ror:8 row_mask:0xf bank_mask:0xf
    v_mov_b32 v82, v80
    s_nop 1
    v_permlane16_swap_b32 v80, v82
    v_max_f32 v80, v80, v82
    v_mov_b32 v82, v80
    s_nop 1
    v_permlane32_swap_b32 v80, v82
    v_max_f32 v80, v80, v82
    s_mov_b32 s86, 0x3dd53b95
    v_mul_f32 v84, s86, v80
    v_fma_f32 v72, v72, s86, -v84
    v_fma_f32 v73, v73, s86, -v84
    v_fma_f32 v74, v74, s86, -v84
    v_fma_f32 v75, v75, s86, -v84
    v_fma_f32 v76, v76, s86, -v84
    v_fma_f32 v77, v77, s86, -v84
    v_fma_f32 v78, v78, s86, -v84
    v_fma_f32 v79, v79, s86, -v84
    v_exp_f32 v72, v72
    v_exp_f32 v73, v73
    v_exp_f32 v74, v74
    v_exp_f32 v75, v75
    v_exp_f32 v76, v76
    v_exp_f32 v77, v77
    v_exp_f32 v78, v78
    v_exp_f32 v79, v79
    v_cvt_pk_bf16_f32 v56, v72, v73
    v_cvt_pk_bf16_f32 v57, v74, v75
    v_cvt_pk_bf16_f32 v58, v76, v77
    v_cvt_pk_bf16_f32 v59, v78, v79
    ds_write_b128 v8, v[56:59]
    v_add_f32 v85, v72, v73
    v_add_f32 v85, v85, v74
    v_add_f32 v85, v85, v75
    v_add_f32 v85, v85, v76
    v_add_f32 v85, v85, v77
    v_add_f32 v85, v85, v78
    v_add_f32 v85, v85, v79
    s_nop 1
    v_add_f32_dpp v85, v85, v85 row_ror:4 row_mask:0xf bank_mask:0xf
    s_nop 1
    v_add_f32_dpp v85, v85, v85 row_ror:8 row_mask:0xf bank_mask:0xf
    v_mov_b32 v82, v85
    s_nop 1
    v_permlane16_swap_b32 v85, v82
    v_add_f32 v85, v85, v82
    v_mov_b32 v82, v85
    s_nop 1
    v_permlane32_swap_b32 v85, v82
    v_add_f32 v85, v85, v82
    s_mov_b64 exec, 1
    buffer_store_dwordx2 v[84:85], v17, s[56:59], s63 offen
    s_mov_b64 exec, -1
    s_cmp_eq_u32 s7, 0
    s_cbranch_scc1 m0_stream2
m0_PV:
    s_waitcnt lgkmcnt(0)
    s_barrier
    ds_read_b128 v[56:59], v7 offset:0
    ds_read_b128 v[60:63], v7 offset:64
    ds_read_b128 v[64:67], v7 offset:128
    ds_read_b128 v[68:71], v7 offset:192
    ds_read_b128 v[72:75], v7 offset:256
    ds_read_b128 v[76:79], v7 offset:320
    ds_read_b128 v[80:83], v7 offset:384
    ds_read_b128 v[84:87], v7 offset:448
    s_cmp_eq_u32 s7, 0
    s_waitcnt lgkmcnt(7)
    v_mfma_f32_16x16x32_bf16 v[24:27], v[56:59], v[92:95], 0
    v_mfma_f32_16x16x32_bf16 v[28:31], v[56:59], v[96:99], 0
    v_mfma_f32_16x16x32_bf16 v[32:35], v[56:59], v[100:103], 0
    ds_read_b128 v[56:59], v7 offset:512
    s_waitcnt lgkmcnt(7)
    v_mfma_f32_16x16x32_bf16 v[24:27], v[60:63], v[104:107], v[24:27]
    v_mfma_f32_16x16x32_bf16 v[28:31], v[60:63], v[108:111], v[28:31]
    v_mfma_f32_16x16x32_bf16 v[32:35], v[60:63], v[112:115], v[32:35]
    ds_read_b128 v[60:63], v7 offset:576
    s_waitcnt lgkmcnt(7)
    s_cbranch_scc1 m0_pv_a
    buffer_load_dwordx4 v[36:39], v13, s[56:59], s64 offen sc1
m0_pv_a:
    v_mfma_f32_16x16x32_bf16 v[24:27], v[64:67], v[116:119], v[24:27]
    v_mfma_f32_16x16x32_bf16 v[28:31], v[64:67], v[120:123], v[28:31]
    v_mfma_f32_16x16x32_bf16 v[32:35], v[64:67], v[124:127], v[32:35]
    ds_read_b128 v[64:67], v7 offset:640
    s_waitcnt lgkmcnt(7)
    v_mfma_f32_16x16x32_bf16 v[24:27], v[68:71], v[128:131], v[24:27]
    v_mfma_f32_16x16x32_bf16 v[28:31], v[68:71], v[132:135], v[28:31]
    v_mfma_f32_16x16x32_bf16 v[32:35], v[68:71], v[136:139], v[32:35]
    ds_read_b128 v[68:71], v7 offset:704
    s_waitcnt lgkmcnt(7)
    v_mfma_f32_16x16x32_bf16 v[24:27], v[72:75], v[140:143], v[24:27]
    v_mfma_f32_16x16x32_bf16 v[28:31], v[72:75], v[144:147], v[28:31]
    v_mfma_f32_16x16x32_bf16 v[32:35], v[72:75], v[148:151], v[32:35]
    ds_read_b128 v[72:75], v7 offset:768
    s_waitcnt lgkmcnt(7)
    v_mfma_f32_16x16x32_bf16 v[24:27], v[76:79], v[152:155], v[24:27]
    v_mfma_f32_16x16x32_bf16 v[28:31], v[76:79], v[156:159], v[28:31]
    v_mfma_f32_16x16x32_bf16 v[32:35], v[76:79], v[160:163], v[32:35]
    ds_read_b128 v[76:79], v7 offset:832
    s_waitcnt lgkmcnt(7)
    v_mfma_f32_16x16x32_bf16 v[24:27], v[80:83], v[164:167], v[24:27]
    v_mfma_f32_16x16x32_bf16 v[28:31], v[80:83], v[168:171], v[28:31]
    v_mfma_f32_16x16x32_bf16 v[32:35], v[80:83], v[172:175], v[32:35]
    ds_read_b128 v[80:83], v7 offset:896
    s_waitcnt lgkmcnt(7)
    v_mfma_f32_16x16x32_bf16 v[24:27], v[84:87], v[176:179], v[24:27]
    v_mfma_f32_16x16x32_bf16 v[28:31], v[84:87], v[180:183], v[28:31]
    v_mfma_f32_16x16x32_bf16 v[32:35], v[84:87], v[184:187], v[32:35]
    ds_read_b128 v[84:87], v7 offset:960
    s_waitcnt lgkmcnt(7)
    s_cbranch_scc1 m0_pv_b
    s_waitcnt vmcnt(0)
m0_pv_b:
    v_mfma_f32_16x16x32_bf16 v[24:27], v[56:59], v[188:191], v[24:27]
    v_max_f32 v40, v36, v38
    v_mfma_f32_16x16x32_bf16 v[28:31], v[56:59], v[192:195], v[28:31]
    v_mfma_f32_16x16x32_bf16 v[32:35], v[56:59], v[196:199], v[32:35]
    v_max_f32_dpp v40, v40, v40 row_ror:8 row_mask:0xf bank_mask:0xf
    s_waitcnt lgkmcnt(6)
    v_mfma_f32_16x16x32_bf16 v[24:27], v[60:63], v[200:203], v[24:27]
    v_max_f32_dpp v40, v40, v40 row_ror:4 row_mask:0xf bank_mask:0xf
    v_mfma_f32_16x16x32_bf16 v[28:31], v[60:63], v[204:207], v[28:31]
    v_mfma_f32_16x16x32_bf16 v[32:35], v[60:63], v[208:211], v[32:35]
    v_max_f32_dpp v40, v40, v40 row_ror:2 row_mask:0xf bank_mask:0xf
    s_waitcnt lgkmcnt(5)
    v_mfma_f32_16x16x32_bf16 v[24:27], v[64:67], v[212:215], v[24:27]
    v_max_f32_dpp v40, v40, v40 row_ror:1 row_mask:0xf bank_mask:0xf
    v_mfma_f32_16x16x32_bf16 v[28:31], v[64:67], v[216:219], v[28:31]
    v_sub_f32 v41, v36, v40
    v_mfma_f32_16x16x32_bf16 v[32:35], v[64:67], v[220:223], v[32:35]
    v_sub_f32 v42, v38, v40
    s_waitcnt lgkmcnt(4)
    v_mfma_f32_16x16x32_bf16 v[24:27], v[68:71], v[224:227], v[24:27]
    v_exp_f32 v41, v41
    v_mfma_f32_16x16x32_bf16 v[28:31], v[68:71], v[228:231], v[28:31]
    v_exp_f32 v42, v42
    v_mfma_f32_16x16x32_bf16 v[32:35], v[68:71], v[232:235], v[32:35]
    v_mul_f32 v43, v41, v37
    s_waitcnt lgkmcnt(3)
    v_mfma_f32_16x16x32_bf16 v[24:27], v[72:75], v[236:239], v[24:27]
    v_fmac_f32 v43, v42, v39
    v_mfma_f32_16x16x32_bf16 v[28:31], v[72:75], v[240:243], v[28:31]
    v_mfma_f32_16x16x32_bf16 v[32:35], v[72:75], v[244:247], v[32:35]
    v_add_f32_dpp v43, v43, v43 row_ror:8 row_mask:0xf bank_mask:0xf
    s_waitcnt lgkmcnt(2)
    v_mfma_f32_16x16x32_bf16 v[24:27], v[76:79], v[248:251], v[24:27]
    v_add_f32_dpp v43, v43, v43 row_ror:4 row_mask:0xf bank_mask:0xf
    v_mfma_f32_16x16x32_bf16 v[28:31], v[76:79], v[252:255], v[28:31]
    v_mfma_f32_16x16x32_bf16 v[32:35], v[76:79], a[228:231], v[32:35]
    v_add_f32_dpp v43, v43, v43 row_ror:2 row_mask:0xf bank_mask:0xf
    s_waitcnt lgkmcnt(1)
    v_mfma_f32_16x16x32_bf16 v[24:27], v[80:83], a[232:235], v[24:27]
    v_add_f32_dpp v43, v43, v43 row_ror:1 row_mask:0xf bank_mask:0xf
    v_mfma_f32_16x16x32_bf16 v[28:31], v[80:83], a[236:239], v[28:31]
    v_cmp_u_f32 vcc, v43, v43
    v_mfma_f32_16x16x32_bf16 v[32:35], v[80:83], a[240:243], v[32:35]
    v_rcp_f32 v43, v43
    s_waitcnt lgkmcnt(0)
    v_mfma_f32_16x16x32_bf16 v[24:27], v[84:87], a[244:247], v[24:27]
    v_mul_f32 v41, v41, v43
    v_mfma_f32_16x16x32_bf16 v[28:31], v[84:87], a[248:251], v[28:31]
    v_mul_f32 v42, v42, v43
    v_mfma_f32_16x16x32_bf16 v[32:35], v[84:87], a[252:255], v[32:35]
    s_cbranch_vccnz m0_ML_rt
m0_ML_ok:
    s_nop 2
    v_mul_f32_dpp v44, v41, v24 row_newbcast:0 row_mask:0x1 bank_mask:0xf
    s_nop 0
    v_mul_f32_dpp v44, v41, v28 row_newbcast:0 row_mask:0x2 bank_mask:0xf
    s_nop 0
    v_mul_f32_dpp v44, v41, v32 row_newbcast:0 row_mask:0x4 bank_mask:0xf
    v_fmac_f32_dpp v44, v42, v25 row_newbcast:0 row_mask:0x1 bank_mask:0xf
    v_fmac_f32_dpp v44, v42, v29 row_newbcast:0 row_mask:0x2 bank_mask:0xf
    v_fmac_f32_dpp v44, v42, v33 row_newbcast:0 row_mask:0x4 bank_mask:0xf
    v_fmac_f32_dpp v44, v41, v26 row_newbcast:1 row_mask:0x1 bank_mask:0xf
    v_fmac_f32_dpp v44, v41, v30 row_newbcast:1 row_mask:0x2 bank_mask:0xf
    v_fmac_f32_dpp v44, v41, v34 row_newbcast:1 row_mask:0x4 bank_mask:0xf
    v_fmac_f32_dpp v44, v42, v27 row_newbcast:1 row_mask:0x1 bank_mask:0xf
    v_fmac_f32_dpp v44, v42, v31 row_newbcast:1 row_mask:0x2 bank_mask:0xf
    v_fmac_f32_dpp v44, v42, v35 row_newbcast:1 row_mask:0x4 bank_mask:0xf
    s_nop 1
    v_mov_b32_dpp v45, v44 row_shl:1 row_mask:0xf bank_mask:0xf
    v_cvt_pk_bf16_f32 v44, v44, v45
    s_mov_b64 exec, s[90:91]
    buffer_store_dword v44, v18, s[56:59], s65 offen
    s_mov_b64 exec, -1
m0_O:
    s_cmp_eq_u32 s7, 0
    s_cbranch_scc1 m0_stream3
    s_barrier
    s_mul_i32 s86, s3, 10240
    s_sub_u32 s86, 155648, s86
    v_add_u32 v50, s86, v21
    ds_read_b64_tr_b16 v[56:57], v21 offset:0
    ds_read_b64_tr_b16 v[58:59], v21 offset:256
    ds_read_b64_tr_b16 v[60:61], v21 offset:32
    ds_read_b64_tr_b16 v[62:63], v21 offset:288
    ds_read_b64_tr_b16 v[64:65], v21 offset:2048
    ds_read_b64_tr_b16 v[66:67], v21 offset:2304
    ds_read_b64_tr_b16 v[68:69], v21 offset:2080
    ds_read_b64_tr_b16 v[70:71], v21 offset:2336
    ds_read_b64_tr_b16 v[72:73], v21 offset:4096
    ds_read_b64_tr_b16 v[74:75], v21 offset:4352
    ds_read_b64_tr_b16 v[76:77], v21 offset:4128
    ds_read_b64_tr_b16 v[78:79], v21 offset:4384
    ds_read_b64_tr_b16 v[80:81], v50 offset:0
    ds_read_b64_tr_b16 v[82:83], v50 offset:256
    ds_read_b64_tr_b16 v[84:85], v50 offset:32
    ds_read_b64_tr_b16 v[86:87], v50 offset:288
    v_and_b32 v49, 7, v1
    v_lshlrev_b32 v48, 3, v16
    v_lshl_add_u32 v48, v49, 4, v48
m0_o_b:
    s_mov_b32 exec_lo, 0x00ff00ff
    s_mov_b32 exec_hi, 0x00ff00ff
    buffer_load_dwordx4 v[24:27], v48, s[56:59], s66 offen offset:0 sc1
    buffer_load_dwordx4 v[28:31], v48, s[56:59], s66 offen offset:512 sc1
    buffer_load_dwordx4 v[32:35], v48, s[56:59], s66 offen offset:1024 sc1
    buffer_load_dwordx4 v[36:39], v48, s[56:59], s66 offen offset:1536 sc1
    s_mov_b64 exec, -1
    s_sleep 1
m0_O_try:
    s_mov_b32 exec_lo, 0x00ff00ff
    s_mov_b32 exec_hi, 0x00ff00ff
    buffer_load_dwordx4 v[24:27], v48, s[56:59], s66 offen offset:0 sc1
    buffer_load_dwordx4 v[28:31], v48, s[56:59], s66 offen offset:512 sc1
    buffer_load_dwordx4 v[32:35], v48, s[56:59], s66 offen offset:1024 sc1
    buffer_load_dwordx4 v[36:39], v48, s[56:59], s66 offen offset:1536 sc1
    s_mov_b64 exec, -1
    s_waitcnt vmcnt(7) lgkmcnt(0)
    v_mfma_f32_16x16x32_bf16 v[40:43], v[24:27], v[56:59], 0
    v_mfma_f32_16x16x32_bf16 v[44:47], v[24:27], v[60:63], 0
    s_waitcnt vmcnt(6) lgkmcnt(0)
    v_mfma_f32_16x16x32_bf16 v[40:43], v[28:31], v[64:67], v[40:43]
    v_mfma_f32_16x16x32_bf16 v[44:47], v[28:31], v[68:71], v[44:47]
    s_waitcnt vmcnt(5) lgkmcnt(0)
    v_mfma_f32_16x16x32_bf16 v[40:43], v[32:35], v[72:75], v[40:43]
    v_mfma_f32_16x16x32_bf16 v[44:47], v[32:35], v[76:79], v[44:47]
    s_waitcnt vmcnt(4) lgkmcnt(0)
    v_mfma_f32_16x16x32_bf16 v[40:43], v[36:39], v[80:83], v[40:43]
    v_mfma_f32_16x16x32_bf16 v[44:47], v[36:39], v[84:87], v[44:47]
    s_nop 6
    v_pk_add_f32 v[40:41], v[40:41], v[42:43]
    v_pk_add_f32 v[44:45], v[44:45], v[46:47]
    v_add_f32 v40, v40, v41
    v_add_f32 v44, v44, v45
    s_nop 1
    v_permlane16_swap_b32 v40, v44
    v_add_f32 v40, v40, v44
    s_mov_b32 exec_hi, 0
    v_cmp_u_f32 vcc, v40, v40
    s_xor_b32 s86, s67, 8192
    s_cbranch_vccnz m0_O_rt
m0_O_ok:
    buffer_store_dword v40, v17, s[56:59], s67 offen sc1
    buffer_store_dword v40, v17, s[56:59], s86 offen sc1
    s_mov_b64 exec, -1
    s_waitcnt vmcnt(2)
    s_barrier
    s_cmp_eq_u32 s7, 2
    s_cbranch_scc0 m0_winB
    v_lshrrev_b32 v54, 3, v1
    v_mul_u32_u24 v54, 1536, v54
    v_xor_b32 v55, v2, v16
    v_and_b32 v55, 0x70, v55
    v_add_u32 v54, v54, v55
    v_xor_b32 v55, 64, v54
    s_mul_i32 s86, s3, 12288
    s_add_u32 m0, s86, 0
    s_add_u32 s87, s84, 0
    buffer_load_dwordx4 v54, s[24:27], s87 offen  lds
    s_add_u32 m0, s86, 1024
    s_add_u32 s87, s84, 12288
    buffer_load_dwordx4 v55, s[24:27], s87 offen  lds
    s_add_u32 m0, s86, 2048
    s_add_u32 s87, s84, 128
    buffer_load_dwordx4 v54, s[24:27], s87 offen  lds
    s_add_u32 m0, s86, 3072
    s_add_u32 s87, s84, 12416
    buffer_load_dwordx4 v55, s[24:27], s87 offen  lds
    s_add_u32 m0, s86, 4096
    s_add_u32 s87, s84, 256
    buffer_load_dwordx4 v54, s[24:27], s87 offen  lds
    s_add_u32 m0, s86, 5120
    s_add_u32 s87, s84, 12544
    buffer_load_dwordx4 v55, s[24:27], s87 offen  lds
    s_branch m0_next
m0_winB:
    s_cmp_eq_u32 s7, 1
    s_cbranch_scc0 m0_next
    v_lshrrev_b32 v54, 2, v1
    v_mul_u32_u24 v54, 1280, v54
    v_and_b32 v55, 3, v1
    v_lshl_add_u32 v54, v55, 4, v54
    s_mul_i32 s86, s3, 12288
    s_add_u32 m0, s86, 0
    s_add_u32 s87, s83, 0
    buffer_load_dwordx4 v54, s[20:23], s87 offen  lds
    s_add_u32 m0, s86, 1024
    s_add_u32 s87, s83, 20480
    buffer_load_dwordx4 v54, s[20:23], s87 offen  lds
    s_add_u32 m0, s86, 2048
    s_add_u32 s87, s83, 40960
    buffer_load_dwordx4 v54, s[20:23], s87 offen  lds
    s_add_u32 m0, s86, 3072
    s_add_u32 s87, s83, 61440
    buffer_load_dwordx4 v54, s[20:23], s87 offen  lds
    s_add_u32 m0, s86, 4096
    s_add_u32 s87, s83, 81920
    buffer_load_dwordx4 v54, s[20:23], s87 offen  lds
    s_add_u32 m0, s86, 5120
    s_add_u32 s87, s83, 102400
    buffer_load_dwordx4 v54, s[20:23], s87 offen  lds
    s_lshl_b32 s86, s3, 11
    s_add_u32 m0, s86, 155648
    s_add_u32 s87, s83, 122880
    buffer_load_dwordx4 v54, s[20:23], s87 offen  lds
    s_add_u32 m0, s86, 156672
    s_add_u32 s87, s83, 143360
    buffer_load_dwordx4 v54, s[20:23], s87 offen  lds
    v_mov_b32 v88, -1
    v_mov_b32 v89, -1
    v_mov_b32 v90, -1
    v_mov_b32 v91, -1
    s_lshl_b32 s87, s4, 5
    s_add_u32 s87, s87, s5
    s_lshl_b32 s87, s87, 2
    s_add_u32 s87, s87, s3
    s_lshl_b32 s87, s87, 10
    s_add_u32 s14, s87, 4653056
    s_lshr_b32 s86, s5, 4
    s_mul_i32 s86, s86, 294912
    s_and_b32 s87, s5, 15
    s_lshl_b32 s87, s87, 2
    s_add_u32 s87, s87, s3
    s_mul_i32 s87, s87, 576
    s_add_u32 s86, s86, s87
    s_mul_i32 s87, s4, 36864
    s_add_u32 s86, s86, s87
    s_add_u32 s86, s86, 5701632
    s_mov_b32 s18, s86
    s_add_u32 s30, s67, 2097152
    s_xor_b32 s38, s30, 8192
    s_and_b32 s87, s5, 15
    s_lshl_b32 s87, s87, 2
    s_add_u32 s87, s87, s3
    s_mul_i32 s87, s87, 96
    s_lshr_b32 s98, s5, 4
    s_lshl_b32 s98, s98, 13
    s_add_u32 s87, s87, s98
    s_mul_i32 s98, s4, 16640
    s_add_u32 s87, s87, s98
    s_add_u32 s87, s87, 4194304
    s_mov_b32 s34, s87
    s_and_b32 vcc_lo, s5, 7
    s_lshl_b32 vcc_lo, vcc_lo, 1
    v_add_u32 v13, vcc_lo, v23
    v_and_b32 v13, 15, v13
    v_lshlrev_b32 v13, 4, v13
    v_and_b32 v7, 3, v1
    v_lshl_add_u32 v7, v7, 10, v16
    v_add_u32 v7, 151552, v7
    s_mul_i32 vcc_lo, s3, 1280
    s_add_u32 vcc_lo, vcc_lo, 151552
    v_and_b32 v8, 0xf0, v17
    v_add_u32 v8, vcc_lo, v8
    s_mul_i32 s86, s3, 6144
    s_add_u32 s86, s86, 4294897664
    v_add_u32 v14, s86, v14
    v_add_u32 v52, s86, v5
    v_cmp_ne_u32 vcc, 151808, v5
    s_nop 1
    v_cndmask_b32 v5, v5, v52, vcc
    v_add_u32 v52, s86, v6
    v_cmp_ne_u32 vcc, 151808, v6
    s_nop 1
    v_cndmask_b32 v6, v6, v52, vcc
    v_mov_b32 v48, 0
    v_mov_b32 v49, 0
    v_mov_b32 v50, 0
    v_mov_b32 v51, 0
    s_lshl_b32 s86, s3, 10
    s_add_u32 s86, s86, 151552
    v_add_u32 v52, s86, v2
    ds_write_b128 v52, v[48:51]
m0_next:
m0_E:
    s_cmp_ge_u32 s0, 20
    s_nop 0
    s_cbranch_scc1 m0_noE
    s_xor_b32 s86, s0, s4
    s_and_b32 s86, s86, 7
    s_cselect_b32 s86, s7, 0
    s_cmp_eq_u32 s86, 3
    s_cbranch_scc1 m0_done
    s_sleep 2
    s_add_u32 s86, s68, 4096
    v_lshrrev_b32 v51, 2, v16
    buffer_load_dwordx4 v[24:27], v2, s[56:59], s68 offen offset:0 sc1
    buffer_load_dwordx4 v[28:31], v2, s[56:59], s68 offen offset:1024 sc1
    buffer_load_dwordx4 v[32:35], v2, s[56:59], s68 offen offset:2048 sc1
    buffer_load_dwordx4 v[36:39], v2, s[56:59], s68 offen offset:3072 sc1
    buffer_load_dwordx4 v[40:43], v2, s[56:59], s86 offen offset:0 sc1
    buffer_load_dwordx4 v[44:47], v2, s[56:59], s86 offen offset:1024 sc1
    s_sleep 6
m0_E_try:
    buffer_load_dwordx4 v[56:59], v2, s[56:59], s68 offen offset:0 sc1
    buffer_load_dwordx4 v[60:63], v2, s[56:59], s68 offen offset:1024 sc1
    buffer_load_dwordx4 v[64:67], v2, s[56:59], s68 offen offset:2048 sc1
    buffer_load_dwordx4 v[68:71], v2, s[56:59], s68 offen offset:3072 sc1
    buffer_load_dwordx4 v[72:75], v2, s[56:59], s86 offen offset:0 sc1
    buffer_load_dwordx4 v[76:79], v2, s[56:59], s86 offen offset:1024 sc1
    s_waitcnt vmcnt(10)
    v_pk_add_f32 v[24:25], v[24:25], v[28:29]
    v_pk_add_f32 v[26:27], v[26:27], v[30:31]
    s_waitcnt vmcnt(9)
    v_pk_add_f32 v[24:25], v[24:25], v[32:33]
    v_pk_add_f32 v[26:27], v[26:27], v[34:35]
    s_waitcnt vmcnt(8)
    v_pk_add_f32 v[24:25], v[24:25], v[36:37]
    v_pk_add_f32 v[26:27], v[26:27], v[38:39]
    s_waitcnt vmcnt(7)
    v_pk_add_f32 v[24:25], v[24:25], v[40:41]
    v_pk_add_f32 v[26:27], v[26:27], v[42:43]
    s_waitcnt vmcnt(6)
    v_pk_add_f32 v[24:25], v[24:25], v[44:45]
    v_pk_add_f32 v[26:27], v[26:27], v[46:47]
    s_nop 0
    v_permlane16_swap_b32 v24, v25
    v_permlane16_swap_b32 v26, v27
    v_add_f32 v24, v24, v25
    v_add_f32 v26, v26, v27
    s_nop 1
    v_permlane32_swap_b32 v24, v26
    v_add_f32 v24, v24, v26
    v_add_f32 v48, v24, v19
    s_nop 0
    v_add_f32_dpp v48, v24, v48 row_ror:8 row_mask:0xf bank_mask:0xf
    v_cmp_u_f32 vcc, v48, v48
    v_cvt_pk_bf16_f32 v48, v48, v48
    s_cbranch_vccz m0_E_ok
    buffer_load_dwordx4 v[24:27], v2, s[56:59], s68 offen offset:0 sc1
    buffer_load_dwordx4 v[28:31], v2, s[56:59], s68 offen offset:1024 sc1
    buffer_load_dwordx4 v[32:35], v2, s[56:59], s68 offen offset:2048 sc1
    buffer_load_dwordx4 v[36:39], v2, s[56:59], s68 offen offset:3072 sc1
    buffer_load_dwordx4 v[40:43], v2, s[56:59], s86 offen offset:0 sc1
    buffer_load_dwordx4 v[44:47], v2, s[56:59], s86 offen offset:1024 sc1
    s_waitcnt vmcnt(10)
    v_pk_add_f32 v[56:57], v[56:57], v[60:61]
    v_pk_add_f32 v[58:59], v[58:59], v[62:63]
    s_waitcnt vmcnt(9)
    v_pk_add_f32 v[56:57], v[56:57], v[64:65]
    v_pk_add_f32 v[58:59], v[58:59], v[66:67]
    s_waitcnt vmcnt(8)
    v_pk_add_f32 v[56:57], v[56:57], v[68:69]
    v_pk_add_f32 v[58:59], v[58:59], v[70:71]
    s_waitcnt vmcnt(7)
    v_pk_add_f32 v[56:57], v[56:57], v[72:73]
    v_pk_add_f32 v[58:59], v[58:59], v[74:75]
    s_waitcnt vmcnt(6)
    v_pk_add_f32 v[56:57], v[56:57], v[76:77]
    v_pk_add_f32 v[58:59], v[58:59], v[78:79]
    s_nop 0
    v_permlane16_swap_b32 v56, v57
    v_permlane16_swap_b32 v58, v59
    v_add_f32 v56, v56, v57
    v_add_f32 v58, v58, v59
    s_nop 1
    v_permlane32_swap_b32 v56, v58
    v_add_f32 v56, v56, v58
    v_add_f32 v48, v56, v19
    s_nop 0
    v_add_f32_dpp v48, v56, v48 row_ror:8 row_mask:0xf bank_mask:0xf
    v_cmp_u_f32 vcc, v48, v48
    v_cvt_pk_bf16_f32 v48, v48, v48
    s_cbranch_vccnz m0_E_rt
m0_E_ok:
    s_mov_b32 exec_lo, 0x00ff00ff
    s_mov_b32 exec_hi, 0x00ff00ff
    s_cmp_eq_u32 s7, 3
    s_cbranch_scc1 m0_final
    buffer_store_short v48, v20, s[56:59], s69 offen
    s_mov_b64 exec, -1
    v_and_b32 v49, 0xffff0000, v48
    v_and_b32 v19, 0xffff0000, v48
    v_mul_f32 v50, v49, v49
    s_nop 1
    v_permlane16_swap_b32 v49, v50
    v_add_f32 v49, v49, v50
    v_mov_b32 v50, v49
    s_nop 1
    v_permlane32_swap_b32 v49, v50
    v_add_f32 v49, v49, v50
    s_nop 1
    v_add_f32_dpp v49, v49, v49 row_ror:4 row_mask:0xf bank_mask:0xf
    s_nop 1
    v_add_f32_dpp v49, v49, v49 row_ror:2 row_mask:0xf bank_mask:0xf
    s_nop 1
    v_add_f32_dpp v49, v49, v49 row_ror:1 row_mask:0xf bank_mask:0xf
    s_mov_b64 exec, 0x10001
    buffer_store_dword v49, v51, s[56:59], s71 offen
    s_mov_b64 exec, -1
    s_waitcnt vmcnt(2)
m0_noE:
    s_lshr_b32 s86, s10, s7
    s_and_b32 s86, s86, 1
    s_lshl_b32 s86, s86, 13
    s_xor_b32 s68, s68, s86
    s_xor_b32 s74, s74, s86
    s_xor_b32 s79, s79, s86
    s_xor_b32 s80, s80, s86
    s_xor_b32 s67, s67, s86
    s_xor_b32 s73, s73, s86
    s_add_u32 s7, s7, 1
    s_add_u32 s56, s56, 2097152
    s_addc_u32 s57, s57, 0
    s_cmp_eq_u32 s7, 4
    s_cbranch_scc0 m0_layer
    s_branch m0_done
m0_layerB:
    s_waitcnt lgkmcnt(5)
    v_mfma_f32_16x16x32_bf16 v[28:31], a[216:219], v[32:35], 0
    v_mfma_f32_16x16x32_bf16 v[24:27], a[192:195], v[32:35], 0
    s_waitcnt lgkmcnt(4)
    v_mfma_f32_16x16x32_bf16 v[28:31], a[220:223], v[36:39], v[28:31]
    v_mfma_f32_16x16x32_bf16 v[24:27], a[196:199], v[36:39], v[24:27]
    s_waitcnt lgkmcnt(3)
    v_mfma_f32_16x16x32_bf16 v[28:31], a[224:227], v[40:43], v[28:31]
    v_mfma_f32_16x16x32_bf16 v[24:27], a[200:203], v[40:43], v[24:27]
    s_waitcnt lgkmcnt(2)
    v_mfma_f32_16x16x32_bf16 v[24:27], a[204:207], v[44:47], v[24:27]
    s_waitcnt lgkmcnt(1)
    v_mfma_f32_16x16x32_bf16 v[24:27], a[208:211], v[48:51], v[24:27]
    s_waitcnt lgkmcnt(0)
    v_mfma_f32_16x16x32_bf16 v[24:27], a[212:215], v[52:55], v[24:27]
    s_mov_b32 s86, 0x3dd53b95
    s_xor_b32 s87, s73, 8192
    v_mov_b32_dpp v33, v28 quad_perm:[0,0,0,0] row_mask:0xf bank_mask:0xf
    v_add_f32_dpp v33, v29, v33 quad_perm:[1,1,1,1] row_mask:0xf bank_mask:0xf
    v_add_f32_dpp v33, v30, v33 quad_perm:[2,2,2,2] row_mask:0xf bank_mask:0xf
    v_add_f32_dpp v33, v31, v33 quad_perm:[3,3,3,3] row_mask:0xf bank_mask:0xf
    v_mul_f32 v33, s86, v33
    s_nop 1
    v_mov_b32_dpp v35, v33 row_shl:4 row_mask:0xf bank_mask:0xf
    v_cvt_pk_bf16_f32 v33, v33, v35
    v_mov_b32_dpp v32, v24 quad_perm:[0,0,0,0] row_mask:0xf bank_mask:0xf
    v_add_f32_dpp v32, v25, v32 quad_perm:[1,1,1,1] row_mask:0xf bank_mask:0xf
    v_add_f32_dpp v32, v26, v32 quad_perm:[2,2,2,2] row_mask:0xf bank_mask:0xf
    v_add_f32_dpp v32, v27, v32 quad_perm:[3,3,3,3] row_mask:0xf bank_mask:0xf
    v_mul_f32 v32, s86, v32
    s_nop 1
    v_mov_b32_dpp v34, v32 row_shl:4 row_mask:0xf bank_mask:0xf
    v_cvt_pk_bf16_f32 v32, v32, v34
    v_cndmask_b32 v32, v32, v33, s[100:101]
    s_mov_b64 exec, s[94:95]
    buffer_store_dword v32, v15, s[56:59], s73 offen sc1
    buffer_store_dword v32, v15, s[56:59], s87 offen sc1
    s_mov_b64 exec, -1
    s_barrier
    s_cmp_lg_u32 s7, 1
    s_cbranch_scc1 m0_noql
    s_lshl_b32 s86, s5, 2
    s_add_u32 s86, s86, s3
    s_cmp_lt_u32 s86, 108
    s_cselect_b32 s98, 0, 0x40000000
    s_mul_i32 s86, s86, 9216
    s_mul_i32 s87, s4, 983040
    s_add_u32 s86, s86, s87
    s_lshl_b32 s87, s3, 11
    s_add_u32 m0, s87, 156672
    v_lshlrev_b32 v29, 7, v1
    v_or_b32 v29, s98, v29
    s_mov_b32 exec_lo, 0xffffffff
    s_mov_b32 exec_hi, 0xf
    buffer_load_dword v29, s[40:43], s86 offen lds
    s_mov_b64 exec, -1
    s_lshr_b32 s86, s5, 4
    s_mul_i32 s86, s86, 2097152
    s_and_b32 s87, s5, 15
    s_lshl_b32 s87, s87, 2
    s_add_u32 s87, s87, s3
    s_mul_i32 s87, s87, 576
    s_add_u32 s86, s86, s87
    s_mul_i32 s87, s4, 36864
    s_add_u32 s86, s86, s87
    s_add_u32 s86, s86, 5701632
    s_lshl_b32 s87, s3, 11
    s_add_u32 m0, s87, 156672
    v_lshlrev_b32 v89, 6, v1
    s_mov_b64 exec, 0x1ff
    buffer_load_dword v89, s[56:59], s86 offen sc1 lds
    s_mov_b64 exec, -1
m0_noql:
    s_mov_b32 s98, s74
    s_add_u32 s86, s74, 66560
    v_xor_b32 v7, 64, v4
    s_and_b32 s87, s3, 1
    s_lshl_b32 s87, s87, 3
    v_lshrrev_b32 v48, 3, v1
    v_add_u32 v48, s87, v48
    v_and_b32 v49, 6, v1
    v_lshlrev_b32 v50, 1, v49
    v_xor_b32 v48, v48, v50
    v_lshlrev_b32 v48, 4, v48
    v_lshl_add_u32 v48, v49, 7, v48
    v_and_b32 v49, 1, v1
    v_lshl_add_u32 v48, v49, 3, v48
    s_lshr_b32 s87, s3, 1
    s_lshl_b32 s87, s87, 10
    s_add_u32 s87, s87, 155648
    v_add_u32 v8, s87, v48
    s_sleep 10
m0_S_try:
    buffer_load_dwordx4 v[24:27], v3, s[56:59], s98 offen offset:0 sc1
    buffer_load_dwordx4 v[56:59], v3, s[56:59], s86 offen offset:0 sc1
    buffer_load_dwordx4 v[28:31], v3, s[56:59], s98 offen offset:256 sc1
    buffer_load_dwordx4 v[60:63], v3, s[56:59], s86 offen offset:256 sc1
    buffer_load_dwordx4 v[32:35], v3, s[56:59], s98 offen offset:512 sc1
    buffer_load_dwordx4 v[64:67], v3, s[56:59], s86 offen offset:512 sc1
    buffer_load_dwordx4 v[36:39], v3, s[56:59], s98 offen offset:768 sc1
    buffer_load_dwordx4 v[68:71], v3, s[56:59], s86 offen offset:768 sc1
    buffer_load_dwordx4 v[40:43], v3, s[56:59], s98 offen offset:1024 sc1
    buffer_load_dwordx4 v[72:75], v3, s[56:59], s86 offen offset:1024 sc1
    buffer_load_dwordx4 v[44:47], v3, s[56:59], s98 offen offset:1280 sc1
    buffer_load_dwordx4 v[76:79], v3, s[56:59], s86 offen offset:1280 sc1
    ds_read_b128 v[80:83], v4 offset:0
    ds_read_b128 v[84:87], v7 offset:0
    ds_read_b128 v[88:91], v4 offset:2048
    s_waitcnt vmcnt(11) lgkmcnt(0)
    v_mfma_f32_16x16x32_bf16 v[48:51], v[80:83], v[24:27], 0
    s_waitcnt vmcnt(10)
    v_mfma_f32_16x16x32_bf16 v[52:55], v[80:83], v[56:59], 0
    ds_read_b128 v[80:83], v7 offset:2048
    s_waitcnt vmcnt(9)
    v_mfma_f32_16x16x32_bf16 v[48:51], v[84:87], v[28:31], v[48:51]
    s_waitcnt vmcnt(8)
    v_mfma_f32_16x16x32_bf16 v[52:55], v[84:87], v[60:63], v[52:55]
    ds_read_b128 v[84:87], v4 offset:4096
    s_waitcnt vmcnt(7)
    v_mfma_f32_16x16x32_bf16 v[48:51], v[88:91], v[32:35], v[48:51]
    s_waitcnt vmcnt(6)
    v_mfma_f32_16x16x32_bf16 v[52:55], v[88:91], v[64:67], v[52:55]
    ds_read_b128 v[88:91], v7 offset:4096
    s_waitcnt vmcnt(5) lgkmcnt(2)
    v_mfma_f32_16x16x32_bf16 v[48:51], v[80:83], v[36:39], v[48:51]
    s_waitcnt vmcnt(4)
    v_mfma_f32_16x16x32_bf16 v[52:55], v[80:83], v[68:71], v[52:55]
    s_waitcnt vmcnt(3) lgkmcnt(1)
    v_mfma_f32_16x16x32_bf16 v[48:51], v[84:87], v[40:43], v[48:51]
    s_waitcnt vmcnt(2)
    v_mfma_f32_16x16x32_bf16 v[52:55], v[84:87], v[72:75], v[52:55]
    s_waitcnt vmcnt(1) lgkmcnt(0)
    v_mfma_f32_16x16x32_bf16 v[48:51], v[88:91], v[44:47], v[48:51]
    s_waitcnt vmcnt(0)
    v_mfma_f32_16x16x32_bf16 v[52:55], v[88:91], v[76:79], v[52:55]
    v_lshlrev_b32 v34, 1, v1
    s_nop 6
    v_cmp_u_f32 vcc, v48, v52
    s_cbranch_vccnz m0_S_rt
m0_S_ok:
    ds_write_b128 v22, v[48:51]
    ds_write_b128 v22, v[52:55] offset:1024
    ds_read_b64_tr_b16 v[56:57], v10 offset:0
    ds_read_b64_tr_b16 v[58:59], v10 offset:384
    ds_read_b64_tr_b16 v[60:61], v10 offset:32
    ds_read_b64_tr_b16 v[62:63], v10 offset:416
    ds_read_b64_tr_b16 v[64:65], v10 offset:64
    ds_read_b64_tr_b16 v[66:67], v10 offset:448
    ds_read_b64_tr_b16 v[68:69], v10 offset:768
    ds_read_b64_tr_b16 v[70:71], v10 offset:1152
    ds_read_b64_tr_b16 v[72:73], v10 offset:800
    ds_read_b64_tr_b16 v[74:75], v10 offset:1184
    ds_read_b64_tr_b16 v[76:77], v10 offset:832
    ds_read_b64_tr_b16 v[78:79], v10 offset:1216
    s_waitcnt lgkmcnt(12)
    s_barrier
    ds_read_b64 v[24:25], v8 offset:0
    ds_read_b64 v[26:27], v8 offset:2048
    ds_read_b64 v[28:29], v8 offset:4096
    ds_read_b64 v[30:31], v8 offset:6144
    s_waitcnt lgkmcnt(2)
    v_pk_add_f32 v[24:25], v[24:25], v[26:27]
    s_waitcnt lgkmcnt(0)
    v_pk_add_f32 v[28:29], v[28:29], v[30:31]
    v_pk_add_f32 v[24:25], v[24:25], v[28:29]
    v_max_f32 v32, v24, v25
    s_nop 1
    v_max_f32_dpp v32, v32, v32 quad_perm:[1,0,3,2] row_mask:0xf bank_mask:0xf
    s_nop 1
    v_max_f32_dpp v32, v32, v32 quad_perm:[2,3,0,1] row_mask:0xf bank_mask:0xf
    s_nop 1
    v_max_f32_dpp v32, v32, v32 row_half_mirror row_mask:0xf bank_mask:0xf
    v_ceil_f32 v32, v32
    v_sub_f32 v24, v24, v32
    v_sub_f32 v25, v25, v32
    v_mul_f32 v33, 0x43000000, v32
    v_exp_f32 v24, v24
    v_exp_f32 v25, v25
    s_mov_b64 exec, s[92:93]
    buffer_store_dword v33, v34, s[56:59], s75 offen
    s_mov_b64 exec, -1
    v_cvt_pk_bf16_f32 v24, v24, v25
    buffer_store_dword v24, v11, s[56:59], s81 offen
    ds_read_b64_tr_b16 v[80:81], v10 offset:12288
    ds_read_b64_tr_b16 v[82:83], v10 offset:12672
    ds_read_b64_tr_b16 v[84:85], v10 offset:12320
    ds_read_b64_tr_b16 v[86:87], v10 offset:12704
    v_mov_b32 v88, 0x3f803f80
    v_mov_b32 v89, 0x3f803f80
    v_mov_b32 v90, 0x3f803f80
    v_mov_b32 v91, 0x3f803f80
    s_and_b32 s87, s3, 1
    s_lshl_b32 s87, s87, 3
    s_add_u32 s87, s87, s76
    s_mul_i32 s86, s3, 12288
    v_and_b32 v13, 32, v1
    v_xor_b32 v13, v13, v2
    v_add_u32 v13, s86, v13
    s_sleep 5
m0_R_go:
    buffer_load_dwordx4 v[40:43], v2, s[56:59], s76 offen sc1
    buffer_load_dwordx2 v[44:45], v2, s[56:59], s87 offen sc1
    buffer_load_dwordx4 v[24:27], v2, s[56:59], s82 offen offset:0 sc1
    buffer_load_dwordx4 v[28:31], v2, s[56:59], s82 offen offset:1024 sc1
    buffer_load_dwordx4 v[32:35], v2, s[56:59], s82 offen offset:2048 sc1
    buffer_load_dwordx4 v[36:39], v2, s[56:59], s82 offen offset:3072 sc1
    s_waitcnt vmcnt(5)
    v_maximum3_f32 v40, v40, v41, v42
    v_maximum3_f32 v41, v40, v43, v43
    v_maximum3_f32 v40, v40, v43, v43
    s_waitcnt vmcnt(3)
    v_or3_b32 v7, v24, v25, v26
    v_permlane16_swap_b32 v40, v41
    v_maximum3_f32 v42, v40, v41, v41
    v_maximum3_f32 v40, v40, v41, v41
    s_waitcnt vmcnt(2)
    v_or3_b32 v7, v7, v27, v28
    v_permlane32_swap_b32 v40, v42
    v_maximum3_f32 v8, v40, v42, v42
    v_sub_f32 v54, v8, v44
    v_sub_f32 v55, v8, v45
    v_or3_b32 v7, v7, v29, v30
    v_cvt_u32_f32 v54, v54
    v_cvt_u32_f32 v55, v55
    s_waitcnt vmcnt(1)
    v_or3_b32 v7, v7, v31, v32
    v_min_u32 v54, 0x7fff, v54
    v_min_u32 v55, 0x7fff, v55
    v_pk_sub_u16 v24, v24, v54 op_sel_hi:[1,0] clamp
    v_pk_sub_u16 v25, v25, v54 op_sel_hi:[1,0] clamp
    v_pk_sub_u16 v26, v26, v54 op_sel_hi:[1,0] clamp
    v_pk_sub_u16 v27, v27, v54 op_sel_hi:[1,0] clamp
    s_waitcnt lgkmcnt(0)
    v_pk_sub_u16 v28, v28, v54 op_sel_hi:[1,0] clamp
    v_pk_sub_u16 v29, v29, v54 op_sel_hi:[1,0] clamp
    v_mfma_f32_16x16x32_bf16 v[40:43], v[56:59], v[24:27], 0
    v_pk_sub_u16 v30, v30, v54 op_sel_hi:[1,0] clamp
    v_pk_sub_u16 v31, v31, v54 op_sel_hi:[1,0] clamp
    v_mfma_f32_16x16x32_bf16 v[44:47], v[60:63], v[24:27], 0
    v_or3_b32 v7, v7, v33, v34
    s_waitcnt vmcnt(0)
    v_mfma_f32_16x16x32_bf16 v[48:51], v[64:67], v[24:27], 0
    v_or3_b32 v7, v7, v35, v36
    v_pk_sub_u16 v32, v32, v55 op_sel_hi:[1,0] clamp
    v_pk_sub_u16 v33, v33, v55 op_sel_hi:[1,0] clamp
    v_mfma_f32_16x16x32_bf16 v[40:43], v[68:71], v[28:31], v[40:43]
    ds_read_b64_tr_b16 v[56:57], v10 offset:12352
    ds_read_b64_tr_b16 v[58:59], v10 offset:12736
    ds_read_b64_tr_b16 v[60:61], v10 offset:13056
    ds_read_b64_tr_b16 v[62:63], v10 offset:13440
    ds_read_b64_tr_b16 v[64:65], v10 offset:13088
    ds_read_b64_tr_b16 v[66:67], v10 offset:13472
    ds_read_b64_tr_b16 v[68:69], v10 offset:13120
    ds_read_b64_tr_b16 v[70:71], v10 offset:13504
    v_pk_sub_u16 v34, v34, v55 op_sel_hi:[1,0] clamp
    v_pk_sub_u16 v35, v35, v55 op_sel_hi:[1,0] clamp
    v_mfma_f32_16x16x32_bf16 v[44:47], v[72:75], v[28:31], v[44:47]
    v_or3_b32 v7, v7, v37, v38
    v_or_b32 v7, v7, v39
    v_mfma_f32_16x16x32_bf16 v[48:51], v[76:79], v[28:31], v[48:51]
    v_pk_sub_u16 v36, v36, v55 op_sel_hi:[1,0] clamp
    v_pk_sub_u16 v37, v37, v55 op_sel_hi:[1,0] clamp
    v_mfma_f32_16x16x32_bf16 v[40:43], v[80:83], v[32:35], v[40:43]
    v_pk_sub_u16 v38, v38, v55 op_sel_hi:[1,0] clamp
    v_pk_sub_u16 v39, v39, v55 op_sel_hi:[1,0] clamp
    v_mfma_f32_16x16x32_bf16 v[44:47], v[84:87], v[32:35], v[44:47]
    s_waitcnt lgkmcnt(0)
    v_and_b32 v7, 0x80008000, v7
    v_cmp_ne_u32 vcc, 0, v7
    v_mfma_f32_16x16x32_bf16 v[48:51], v[56:59], v[32:35], v[48:51]
    v_cmp_u_f32 s[98:99], v8, v8
    v_mfma_f32_16x16x32_bf16 v[40:43], v[60:63], v[36:39], v[40:43]
    v_mfma_f32_16x16x32_bf16 v[44:47], v[64:67], v[36:39], v[44:47]
    v_mfma_f32_16x16x32_bf16 v[48:51], v[68:71], v[36:39], v[48:51]
    v_mfma_f32_16x16x32_bf16 v[52:55], v[88:91], v[24:27], 0
    v_xor_b32 v56, 64, v13
    v_mfma_f32_16x16x32_bf16 v[52:55], v[88:91], v[28:31], v[52:55]
    v_xor_b32 v57, 128, v13
    v_mfma_f32_16x16x32_bf16 v[52:55], v[88:91], v[32:35], v[52:55]
    v_xor_b32 v58, 192, v13
    v_mfma_f32_16x16x32_bf16 v[52:55], v[88:91], v[36:39], v[52:55]
    s_or_b64 vcc, vcc, s[98:99]
    s_cbranch_vccnz m0_R_rt
m0_R_ok:
    ds_write_b128 v13, v[40:43]
    ds_write_b128 v56, v[44:47] offset:1024
    ds_write_b128 v57, v[48:51] offset:2048
    s_mov_b32 exec_lo, 0xffff0000
    s_mov_b32 exec_hi, 0
    s_nop 0
    v_mul_f32 v52, 0x3b800000, v8
    s_mov_b64 exec, -1
    ds_write_b128 v58, v[52:55] offset:3072
    v_and_b32 v60, 32, v1
    v_and_b32 v61, 0x1f0, v2
    v_lshl_add_u32 v60, v60, 13, v61
    s_mov_b32 vcc_lo, 0x40404040
    s_mov_b32 vcc_hi, 0x40404040
    s_waitcnt lgkmcnt(0)
    s_barrier
    ds_read_b128 v[24:27], v12 offset:0
    ds_read_b128 v[32:35], v12 offset:12288
    ds_read_b128 v[28:31], v12 offset:256
    ds_read_b128 v[36:39], v12 offset:12544
    s_waitcnt lgkmcnt(2)
    v_pk_add_f32 v[24:25], v[24:25], v[32:33]
    v_pk_add_f32 v[26:27], v[26:27], v[34:35]
    v_cvt_pk_bf16_f32 v40, v24, v25
    v_cvt_pk_bf16_f32 v41, v26, v27
    v_cndmask_b32 v41, v41, v24, vcc
    s_waitcnt lgkmcnt(0)
    v_pk_add_f32 v[28:29], v[28:29], v[36:37]
    v_pk_add_f32 v[30:31], v[30:31], v[38:39]
    v_cvt_pk_bf16_f32 v42, v28, v29
    v_cvt_pk_bf16_f32 v43, v30, v31
    v_cndmask_b32 v40, v40, v28, vcc
    buffer_store_dwordx4 v[40:43], v60, s[56:59], s79 offen sc1
    s_barrier
    v_lshrrev_b32 v54, 2, v1
    v_mul_u32_u24 v54, 1280, v54
    v_and_b32 v55, 3, v1
    v_lshl_add_u32 v54, v55, 4, v54
    s_mul_i32 s86, s3, 12288
    s_add_u32 m0, s86, 0
    s_add_u32 s87, s83, 0
    buffer_load_dwordx4 v54, s[40:43], s87 offen  lds
    s_add_u32 m0, s86, 1024
    s_add_u32 s87, s83, 20480
    buffer_load_dwordx4 v54, s[40:43], s87 offen  lds
    s_add_u32 m0, s86, 2048
    s_add_u32 s87, s83, 40960
    buffer_load_dwordx4 v54, s[40:43], s87 offen  lds
    s_add_u32 m0, s86, 3072
    s_add_u32 s87, s83, 61440
    buffer_load_dwordx4 v54, s[40:43], s87 offen  lds
    s_add_u32 m0, s86, 4096
    s_add_u32 s87, s83, 81920
    buffer_load_dwordx4 v54, s[40:43], s87 offen  lds
    s_add_u32 m0, s86, 5120
    s_add_u32 s87, s83, 102400
    buffer_load_dwordx4 v54, s[40:43], s87 offen  lds
    s_lshl_b32 s86, s3, 11
    s_add_u32 m0, s86, 155648
    s_add_u32 s87, s83, 122880
    buffer_load_dwordx4 v54, s[40:43], s87 offen  lds
    s_add_u32 m0, s86, 156672
    s_add_u32 s87, s83, 143360
    buffer_load_dwordx4 v54, s[40:43], s87 offen  lds
    v_lshrrev_b32 v52, 3, v1
    v_and_b32 v53, 0x70, v2
    v_lshl_add_u32 v52, v52, 15, v53
    buffer_load_dwordx4 v[48:51], v52, s[56:59], s80 offen sc1
    v_lshrrev_b32 v55, 4, v1
    v_mul_u32_u24 v55, 24, v55
    v_bfe_u32 v54, v1, 2, 2
    v_add_u32 v55, v55, v54
    v_mul_u32_u24 v55, 384, v55
    v_and_b32 v54, 3, v1
    v_lshl_add_u32 v55, v54, 3, v55
    s_mul_i32 s86, s3, 96
    s_add_u32 s86, s86, 49152
    v_add_u32 v55, s86, v55
    ds_read_b64_tr_b16 v[56:57], v55 offset:0
    ds_read_b64_tr_b16 v[58:59], v55 offset:1536
    ds_read_b64_tr_b16 v[60:61], v55 offset:32
    ds_read_b64_tr_b16 v[62:63], v55 offset:1568
    ds_read_b64_tr_b16 v[64:65], v55 offset:64
    ds_read_b64_tr_b16 v[66:67], v55 offset:1600
    ds_read_b64_tr_b16 v[68:69], v55 offset:3072
    ds_read_b64_tr_b16 v[70:71], v55 offset:4608
    ds_read_b64_tr_b16 v[72:73], v55 offset:3104
    ds_read_b64_tr_b16 v[74:75], v55 offset:4640
    ds_read_b64_tr_b16 v[76:77], v55 offset:3136
    ds_read_b64_tr_b16 v[78:79], v55 offset:4672
    ds_read_b64_tr_b16 v[80:81], v55 offset:6144
    ds_read_b64_tr_b16 v[82:83], v55 offset:7680
    ds_read_b64_tr_b16 v[84:85], v55 offset:6176
    ds_read_b64_tr_b16 v[86:87], v55 offset:7712
    ds_read_b64_tr_b16 v[88:89], v55 offset:6208
    ds_read_b64_tr_b16 v[90:91], v55 offset:7744
    v_lshrrev_b32 v54, 3, v1
    v_lshlrev_b32 v54, 4, v54
    v_xor_b32 v54, v54, v2
    s_lshl_b32 s86, s3, 10
    s_add_u32 s86, s86, 151552
    v_add_u32 v54, s86, v54
    v_and_b32 v36, 32, v1
    v_lshlrev_b32 v36, 6, v36
    v_lshl_add_u32 v36, v23, 7, v36
    v_add_u32 v36, 151552, v36
    v_and_b32 v37, 16, v1
    v_mul_u32_u24 v37, 3, v37
    v_add_u32 v24, 0, v37
    v_xor_b32 v24, v24, v53
    v_add_u32 v24, v24, v36
    v_add_u32 v28, 16, v37
    v_xor_b32 v28, v28, v53
    v_add_u32 v28, v28, v36
    v_add_u32 v32, 32, v37
    v_xor_b32 v32, v32, v53
    v_add_u32 v32, v32, v36
    v_lshrrev_b32 v53, 2, v16
    v_add_u32 v53, v53, v23
    v_and_b32 v53, 15, v53
    v_xor_b32 v36, 6, v53
    v_and_b32 v36, 7, v36
    v_lshlrev_b32 v53, 7, v53
    v_lshl_add_u32 v53, v36, 4, v53
    v_add_u32 v53, 151552, v53
m0_UV_w:
    s_waitcnt vmcnt(0)
    ds_write_b128 v54, v[48:51]
    v_max3_u32 v55, v48, v49, v50
    v_max_u32 v55, v55, v51
    v_cmp_eq_u32 vcc, -1, v55
    s_cbranch_vccnz m0_UV_rt
m0_UV_ok:
    s_waitcnt lgkmcnt(0)
    s_barrier
    ds_read_b64 v[48:49], v53
    ds_read_b128 v[24:27], v24
    ds_read_b128 v[28:31], v28
    ds_read_b128 v[32:35], v32
    s_waitcnt lgkmcnt(3)
    v_max_f32_dpp v50, v48, v48 row_ror:8 row_mask:0xf bank_mask:0xf
    s_waitcnt lgkmcnt(2)
    v_mfma_f32_16x16x32_bf16 v[36:39], v[24:27], v[56:59], 0
    v_max_f32_dpp v50, v50, v50 row_ror:4 row_mask:0xf bank_mask:0xf
    v_mfma_f32_16x16x32_bf16 v[40:43], v[24:27], v[60:63], 0
    v_mfma_f32_16x16x32_bf16 v[44:47], v[24:27], v[64:67], 0
    v_max_f32_dpp v50, v50, v50 row_ror:2 row_mask:0xf bank_mask:0xf
    s_waitcnt lgkmcnt(1)
    v_mfma_f32_16x16x32_bf16 v[36:39], v[28:31], v[68:71], v[36:39]
    v_mfma_f32_16x16x32_bf16 v[40:43], v[28:31], v[72:75], v[40:43]
    v_max_f32_dpp v50, v50, v50 row_ror:1 row_mask:0xf bank_mask:0xf
    v_mfma_f32_16x16x32_bf16 v[44:47], v[28:31], v[76:79], v[44:47]
    v_sub_f32 v51, v48, v50
    s_waitcnt lgkmcnt(0)
    v_mfma_f32_16x16x32_bf16 v[36:39], v[32:35], v[80:83], v[36:39]
    v_exp_f32 v51, v51
    v_mfma_f32_16x16x32_bf16 v[40:43], v[32:35], v[84:87], v[40:43]
    v_mul_f32 v52, v51, v49
    v_mfma_f32_16x16x32_bf16 v[44:47], v[32:35], v[88:91], v[44:47]
    s_nop 0
    v_add_f32_dpp v52, v52, v52 row_ror:8 row_mask:0xf bank_mask:0xf
    s_nop 1
    v_add_f32_dpp v52, v52, v52 row_ror:4 row_mask:0xf bank_mask:0xf
    s_nop 1
    v_add_f32_dpp v52, v52, v52 row_ror:2 row_mask:0xf bank_mask:0xf
    v_mul_f32_dpp v24, v51, v36 row_newbcast:0 row_mask:0xf bank_mask:0xf
    v_mul_f32_dpp v25, v51, v40 row_newbcast:0 row_mask:0xf bank_mask:0xf
    v_mul_f32_dpp v26, v51, v44 row_newbcast:0 row_mask:0xf bank_mask:0xf
    v_add_f32_dpp v52, v52, v52 row_ror:1 row_mask:0xf bank_mask:0xf
    v_fmac_f32_dpp v24, v51, v37 row_newbcast:1 row_mask:0xf bank_mask:0xf
    v_fmac_f32_dpp v25, v51, v41 row_newbcast:1 row_mask:0xf bank_mask:0xf
    v_fmac_f32_dpp v26, v51, v45 row_newbcast:1 row_mask:0xf bank_mask:0xf
    v_rcp_f32 v52, v52
    v_fmac_f32_dpp v24, v51, v38 row_newbcast:2 row_mask:0xf bank_mask:0xf
    v_fmac_f32_dpp v25, v51, v42 row_newbcast:2 row_mask:0xf bank_mask:0xf
    v_fmac_f32_dpp v26, v51, v46 row_newbcast:2 row_mask:0xf bank_mask:0xf
    v_fmac_f32_dpp v24, v51, v39 row_newbcast:3 row_mask:0xf bank_mask:0xf
    v_fmac_f32_dpp v25, v51, v43 row_newbcast:3 row_mask:0xf bank_mask:0xf
    v_fmac_f32_dpp v26, v51, v47 row_newbcast:3 row_mask:0xf bank_mask:0xf
    v_mov_b32 v27, v26
    v_permlane16_swap_b32 v24, v25
    v_add_f32 v24, v24, v25
    v_permlane16_swap_b32 v26, v27
    v_add_f32 v26, v26, v27
    s_nop 1
    v_permlane32_swap_b32 v24, v26
    v_add_f32 v24, v24, v26
    v_mul_f32 v24, v24, v52
    s_nop 1
    v_mov_b32_dpp v25, v24 row_shl:1 row_mask:0xf bank_mask:0xf
    v_cvt_pk_bf16_f32 v24, v24, v25
    s_mov_b64 exec, s[90:91]
    buffer_store_dword v24, v18, s[56:59], s65 offen
    s_mov_b64 exec, -1
    s_branch m0_O
m0_final:
    s_lshl_b32 s86, s0, 6
    buffer_store_short v48, v20, s[48:51], s86 offen
m0_done:
    s_endpgm
m0_O0_rt:
    s_sub_u32 s60, s60, 1
    s_nop 7
    s_cbranch_scc0 m0_O0_try
    s_mov_b32 s60, 0
    s_branch m0_O0_ok
m0_P_rt:
    s_sub_u32 s60, s60, 1
    s_nop 7
    s_cbranch_scc0 m0_P_try
    s_mov_b32 s60, 0
    s_branch m0_P_ok
m0_Q_rt:
    s_sub_u32 s60, s60, 1
    s_nop 7
    s_cbranch_scc0 m0_Q_try
    s_mov_b32 s60, 0
    s_branch m0_Q_ok
m0_ML_rt:
    s_sub_u32 s60, s60, 1
    s_nop 7
    s_cbranch_scc0 m0_ML_try
    s_mov_b32 s60, 0
    s_branch m0_ML_ok
m0_O_rt:
    s_sub_u32 s60, s60, 1
    s_nop 7
    s_cbranch_scc0 m0_O_try
    s_mov_b32 s60, 0
    s_branch m0_O_ok
m0_E_rt:
    s_sub_u32 s60, s60, 1
    s_nop 7
    s_cbranch_scc0 m0_E_try
    s_mov_b32 s60, 0
    s_branch m0_E_ok
m0_S_rt:
    s_sub_u32 s60, s60, 1
    s_nop 7
    s_cbranch_scc0 m0_S_try
    s_mov_b32 s60, 0
    s_branch m0_S_ok
m0_R_rt:
    s_sub_u32 s60, s60, 1
    s_nop 7
    s_cbranch_scc0 m0_R_try
    s_mov_b32 s60, 0
    s_branch m0_R_ok
m0_UV_rt:
    s_sub_u32 s60, s60, 1
    s_nop 7
    s_cbranch_scc0 m0_UV_try
    s_mov_b32 s60, 0
    s_branch m0_UV_ok
m0_O0_try:
    s_mov_b32 exec_lo, 0x00ff00ff
    s_mov_b32 exec_hi, 0x00ff00ff
    buffer_load_dwordx4 v[24:27], v48, s[56:59], s66 offen offset:0 sc1
    buffer_load_dwordx4 v[28:31], v48, s[56:59], s66 offen offset:512 sc1
    buffer_load_dwordx4 v[32:35], v48, s[56:59], s66 offen offset:1024 sc1
    buffer_load_dwordx4 v[36:39], v48, s[56:59], s66 offen offset:1536 sc1
    s_mov_b64 exec, -1
    s_waitcnt vmcnt(0)
    s_branch m0_O0_go
m0_P_try:
    s_mov_b64 exec, 0x3ff
    buffer_load_dwordx4 v[40:43], v2, s[56:59], s72 offen sc1
    s_mov_b64 exec, s[88:89]
    buffer_load_dwordx4 v[24:27], v16, s[56:59], s70 offen offset:0 sc1
    buffer_load_dwordx4 v[28:31], v16, s[56:59], s70 offen offset:64 sc1
    buffer_load_dwordx4 v[32:35], v16, s[56:59], s70 offen offset:128 sc1
    buffer_load_dwordx4 v[36:39], v16, s[56:59], s70 offen offset:192 sc1
    s_mov_b64 exec, -1
    s_branch m0_P_go
m0_P_rq:
    s_sub_u32 s60, s60, 1
    s_cbranch_scc0 m0_P_try
    s_mov_b32 s60, 0
    s_branch m0_P_rqo
m0_ML_try:
    buffer_load_dwordx4 v[36:39], v13, s[56:59], s64 offen sc1
    s_waitcnt vmcnt(0)
    v_max_f32 v40, v36, v38
    s_nop 1
    v_max_f32_dpp v40, v40, v40 row_ror:8 row_mask:0xf bank_mask:0xf
    s_nop 1
    v_max_f32_dpp v40, v40, v40 row_ror:4 row_mask:0xf bank_mask:0xf
    s_nop 1
    v_max_f32_dpp v40, v40, v40 row_ror:2 row_mask:0xf bank_mask:0xf
    s_nop 1
    v_max_f32_dpp v40, v40, v40 row_ror:1 row_mask:0xf bank_mask:0xf
    v_sub_f32 v41, v36, v40
    v_sub_f32 v42, v38, v40
    v_exp_f32 v41, v41
    v_exp_f32 v42, v42
    v_mul_f32 v43, v41, v37
    v_fmac_f32 v43, v42, v39
    s_nop 1
    v_add_f32_dpp v43, v43, v43 row_ror:8 row_mask:0xf bank_mask:0xf
    s_nop 1
    v_add_f32_dpp v43, v43, v43 row_ror:4 row_mask:0xf bank_mask:0xf
    s_nop 1
    v_add_f32_dpp v43, v43, v43 row_ror:2 row_mask:0xf bank_mask:0xf
    s_nop 1
    v_add_f32_dpp v43, v43, v43 row_ror:1 row_mask:0xf bank_mask:0xf
    v_cmp_u_f32 vcc, v43, v43
    v_rcp_f32 v43, v43
    s_nop 0
    v_mul_f32 v41, v41, v43
    v_mul_f32 v42, v42, v43
    s_cbranch_vccnz m0_ML_rt
    s_nop 0
    s_branch m0_ML_ok
m0_R_try:
    ds_read_b64_tr_b16 v[56:57], v10 offset:0
    ds_read_b64_tr_b16 v[58:59], v10 offset:384
    ds_read_b64_tr_b16 v[60:61], v10 offset:32
    ds_read_b64_tr_b16 v[62:63], v10 offset:416
    ds_read_b64_tr_b16 v[64:65], v10 offset:64
    ds_read_b64_tr_b16 v[66:67], v10 offset:448
    ds_read_b64_tr_b16 v[68:69], v10 offset:768
    ds_read_b64_tr_b16 v[70:71], v10 offset:1152
    s_branch m0_R_go
m0_UV_try:
    buffer_load_dwordx4 v[48:51], v52, s[56:59], s80 offen sc1
    s_branch m0_UV_w
m1_start:
    s_mov_b32 s7, 0
    s_lshr_b32 s4, s2, 5
    s_and_b32 s5, s2, 31
    s_add_u32 s56, s56, 67108864
    s_addc_u32 s57, s57, 0
    v_bfe_u32 v54, v1, 2, 2
    v_lshrrev_b32 v55, 5, v1
    v_lshl_add_u32 v91, v54, 2, v55
    v_mul_u32_u24 v91, 3072, v91
    v_and_b32 v54, 16, v1
    v_lshl_add_u32 v91, v54, 2, v91
    v_and_b32 v55, 3, v1
    v_lshl_add_u32 v91, v55, 4, v91
    s_lshl_b32 s86, s4, 5
    s_add_u32 s86, s86, s5
    s_mul_i32 s79, s86, 196608
    s_mul_i32 s80, s3, 49152
    s_add_u32 s80, s80, s79
    s_waitcnt lgkmcnt(0)
    buffer_load_dwordx4 a[0:3], v91, s[8:11], s80 offen offset:0 nt
    buffer_load_dwordx4 a[4:7], v91, s[8:11], s80 offen offset:128 nt
    buffer_load_dwordx4 a[8:11], v91, s[8:11], s80 offen offset:256 nt
    buffer_load_dwordx4 a[24:27], v91, s[8:11], s80 offen offset:384 nt
    buffer_load_dwordx4 a[28:31], v91, s[8:11], s80 offen offset:512 nt
    buffer_load_dwordx4 a[32:35], v91, s[8:11], s80 offen offset:640 nt
    buffer_load_dwordx4 a[48:51], v91, s[8:11], s80 offen offset:768 nt
    buffer_load_dwordx4 a[52:55], v91, s[8:11], s80 offen offset:896 nt
    s_mov_b32 s99, s7
    s_mov_b32 s7, 0
    v_mov_b32 v64, -1
    v_mov_b32 v65, -1
    v_mov_b32 v66, -1
    v_mov_b32 v67, -1
    s_cmp_lg_u32 s2, 0
    s_nop 0
    s_cbranch_scc1 m1_nolead
    s_lshl_b32 s86, s3, 11
    s_add_u32 s86, s86, 524288
    buffer_store_dwordx4 v[64:67], v2, s[56:59], s86 offen offset:0 sc1
    buffer_store_dwordx4 v[64:67], v2, s[56:59], s86 offen offset:1024 sc1
    s_lshl_b32 s86, s3, 2
    s_mov_b64 exec, 1
    s_waitcnt vmcnt(0)
    buffer_store_dword v64, v2, s[52:55], s86 offen offset:192 sc1
    s_mov_b64 exec, -1
m1_nolead:
    s_lshl_b32 s6, s5, 2
    s_add_u32 s6, s6, s3
    s_sub_u32 s86, s6, 8
    s_cmp_ge_u32 s6, 120
    s_cselect_b32 s6, s86, s6
    s_mul_i32 s86, s6, 2731
    s_lshr_b32 s86, s86, 16
    s_mul_i32 s87, s86, 24
    s_sub_u32 s87, s6, s87
    s_mul_i32 s83, s86, 1572864
    s_mul_i32 s98, s4, 1536
    s_add_u32 s83, s83, s98
    s_lshl_b32 s98, s87, 6
    s_add_u32 s83, s83, s98
    v_lshrrev_b32 v53, 4, v1
    v_mul_u32_u24 v52, 12288, v53
    v_lshlrev_b32 v53, 5, v53
    v_xor_b32 v53, v53, v2
    v_and_b32 v53, 0xf0, v53
    v_add_u32 v52, v52, v53
    v_xor_b32 v53, 128, v52
    s_mul_i32 s98, s3, 393152
    s_add_u32 s98, s98, s83
    s_lshl_b32 vcc_lo, s3, 13
    s_add_u32 m0, vcc_lo, 86016
    s_nop 0
    buffer_load_dwordx4 v52, s[16:19], s98 offen nt lds
    s_add_u32 s98, s98, 49152
    s_add_u32 m0, vcc_lo, 87040
    s_nop 0
    buffer_load_dwordx4 v52, s[16:19], s98 offen nt lds
    s_add_u32 s98, s98, 49152
    s_add_u32 m0, vcc_lo, 88064
    s_nop 0
    buffer_load_dwordx4 v53, s[16:19], s98 offen nt lds
    s_add_u32 s98, s98, 49152
    s_add_u32 m0, vcc_lo, 89088
    s_nop 0
    buffer_load_dwordx4 v53, s[16:19], s98 offen nt lds
    s_add_u32 s98, s98, 49152
    s_add_u32 m0, vcc_lo, 90112
    s_nop 0
    buffer_load_dwordx4 v52, s[16:19], s98 offen nt lds
    s_add_u32 s98, s98, 49152
    s_add_u32 m0, vcc_lo, 91136
    s_nop 0
    buffer_load_dwordx4 v52, s[16:19], s98 offen nt lds
    s_add_u32 s98, s98, 49152
    s_add_u32 m0, vcc_lo, 92160
    s_nop 0
    buffer_load_dwordx4 v53, s[16:19], s98 offen nt lds
    s_add_u32 s98, s98, 49152
    s_add_u32 m0, vcc_lo, 93184
    s_nop 0
    buffer_load_dwordx4 v53, s[16:19], s98 offen nt lds
    s_lshl_b32 s70, s86, 8
    s_mul_i32 s61, s86, 768
    s_mul_i32 s98, s87, 10923
    s_lshr_b32 s98, s98, 16
    s_mul_i32 s86, s98, 3072
    s_add_u32 s61, s61, s86
    s_lshl_b32 s86, s87, 7
    s_add_u32 s61, s61, s86
    s_mul_i32 s86, s4, 36864
    s_add_u32 s61, s61, s86
    s_add_u32 s61, s61, 3604480
    buffer_load_dwordx4 a[56:59], v91, s[8:11], s80 offen offset:1024 nt
    buffer_load_dwordx4 a[72:75], v91, s[8:11], s80 offen offset:1152 nt
    v_lshlrev_b32 v17, 2, v1
    v_and_b32 v23, 15, v1
    v_and_b32 v16, 48, v1
    v_lshrrev_b32 v24, 4, v1
    v_bfe_u32 v25, v1, 2, 2
    v_and_b32 v26, 3, v1
    v_and_b32 v27, 7, v1
    v_lshl_add_u32 v20, v27, 2, v24
    v_lshlrev_b32 v20, 1, v20
    v_lshrrev_b32 v18, 3, v1
    v_lshlrev_b32 v18, 7, v18
    v_lshl_add_u32 v18, v27, 1, v18
    v_mul_u32_u24 v3, 16640, v25
    v_lshl_add_u32 v3, v26, 4, v3
    v_lshl_add_u32 v3, v24, 6, v3
    s_lshl_b32 s86, s3, 11
    s_add_u32 s86, s86, 155648
    v_lshlrev_b32 v22, 2, v16
    v_xor_b32 v22, v22, v2
    v_add_u32 v22, s86, v22
    v_lshlrev_b32 v14, 3, v1
    v_add_u32 v14, s86, v14
    v_lshl_add_u32 v27, v24, 3, v25
    v_lshlrev_b32 v27, 6, v27
    v_lshl_add_u32 v27, v26, 3, v27
    s_mul_i32 s87, s3, 12288
    v_add_u32 v21, s87, v27
    s_lshl_b32 s87, s3, 6
    v_lshlrev_b32 v27, 3, v26
    v_add_u32 v27, s87, v27
    v_lshlrev_b32 v28, 5, v25
    v_xor_b32 v27, v27, v28
    v_and_b32 v28, 16, v1
    v_lshlrev_b32 v28, 3, v28
    v_xor_b32 v27, v27, v28
    v_lshl_add_u32 v28, v24, 3, v25
    v_lshl_add_u32 v9, v28, 8, v27
    v_add_u32 v9, 86016, v9
    v_and_b32 v27, 1, v24
    v_lshl_add_u32 v27, v27, 2, v26
    v_lshlrev_b32 v27, 4, v27
    v_add_u32 v27, s86, v27
    v_lshrrev_b32 v28, 1, v24
    v_mov_b32 v29, 151808
    v_cmp_eq_u32 vcc, v25, v28
    s_nop 1
    v_cndmask_b32 v5, v29, v27, vcc
    v_add_u32 v28, 2, v28
    v_cmp_eq_u32 vcc, v25, v28
    s_nop 1
    v_cndmask_b32 v6, v29, v27, vcc
    s_mul_i32 s87, s3, 12288
    v_add_u32 v10, v16, v25
    v_mul_u32_u24 v10, 96, v10
    v_lshl_add_u32 v10, v26, 3, v10
    s_and_b32 s98, s3, 1
    s_mul_i32 s98, s98, 24576
    s_add_u32 s98, s98, 6144
    v_add_u32 v10, s98, v10
    v_and_b32 v27, 14, v23
    v_lshlrev_b32 v27, 3, v27
    v_xor_b32 v27, v27, v16
    v_lshl_add_u32 v4, v23, 7, v27
    v_add_u32 v4, s87, v4
    v_and_b32 v11, 4, v1
    v_lshlrev_b32 v11, 8, v11
    v_lshl_add_u32 v11, v26, 2, v11
    v_lshrrev_b32 v27, 3, v1
    v_lshl_add_u32 v11, v27, 4, v11
    s_and_b32 s87, s3, 1
    s_lshl_b32 s87, s87, 3
    v_lshrrev_b32 v12, 3, v1
    v_add_u32 v12, s87, v12
    v_and_b32 v27, 7, v1
    v_lshlrev_b32 v28, 1, v27
    v_xor_b32 v12, v12, v28
    v_lshlrev_b32 v12, 4, v12
    v_lshl_add_u32 v12, v27, 9, v12
    s_lshr_b32 s87, s3, 1
    s_mul_i32 s87, s87, 24576
    v_add_u32 v12, s87, v12
    v_lshrrev_b32 v15, 1, v1
    v_lshl_add_u32 v27, v24, 2, 32
    v_cmp_eq_u32 vcc, 1, v23
    s_nop 1
    v_cndmask_b32 v15, v15, v27, vcc
    v_and_b32 v27, 0x30, v15
    v_and_b32 v15, 15, v15
    v_lshl_add_u32 v15, v27, 2, v15
    v_mov_b32 v52, 0x3f803f80
    v_cmp_eq_u32 vcc, 1, v23
    s_nop 1
    v_cndmask_b32 v24, 0, v52, vcc
    v_mov_b32 v25, v24
    v_mov_b32 v26, v24
    v_mov_b32 v27, v24
    v_mov_b32 v28, v24
    v_mov_b32 v29, v24
    v_mov_b32 v30, v24
    v_mov_b32 v31, v24
    v_mov_b32 v32, v24
    v_mov_b32 v33, v24
    v_mov_b32 v34, v24
    v_mov_b32 v35, v24
    v_mov_b32 v36, v24
    v_mov_b32 v37, v24
    v_mov_b32 v38, v24
    v_mov_b32 v39, v24
    v_mov_b32 v40, 0
    v_mov_b32 v41, 0
    v_mov_b32 v42, 0
    v_mov_b32 v43, 0
    s_mov_b64 exec, s[88:89]
    buffer_load_dwordx4 v[24:27], v16, s[44:47], s70 offen offset:0
    buffer_load_dwordx4 v[28:31], v16, s[44:47], s70 offen offset:64
    buffer_load_dwordx4 v[32:35], v16, s[44:47], s70 offen offset:128
    buffer_load_dwordx4 v[36:39], v16, s[44:47], s70 offen offset:192
    s_mov_b64 exec, -1
    buffer_load_dwordx4 v[56:59], v2, s[44:47], 0 offen
    buffer_load_dwordx4 v[60:63], v2, s[44:47], 0 offen offset:1024
    s_lshl_b32 s0, s5, 2
    s_add_u32 s0, s0, s3
    s_sub_u32 s0, s0, 108
    s_min_u32 s86, s0, 19
    s_lshl_b32 s86, s86, 6
    buffer_load_ushort v19, v20, s[44:47], s86 offen
    s_lshl_b32 s86, s5, 2
    s_add_u32 s86, s86, s3
    s_mul_i32 s86, s86, 144
    s_mul_i32 s87, s4, 36864
    s_add_u32 s86, s86, s87
    s_add_u32 s86, s86, 3619840
    s_mov_b64 exec, 0x1ff
    buffer_store_dwordx4 v[64:67], v2, s[56:59], s86 offen sc1
    s_mov_b64 exec, -1
    s_waitcnt vmcnt(21)
    buffer_load_dwordx4 a[76:79], v91, s[8:11], s80 offen offset:1280 nt
    s_waitcnt vmcnt(21)
    buffer_load_dwordx4 a[80:83], v91, s[8:11], s80 offen offset:1408 nt
    s_waitcnt vmcnt(21)
    buffer_load_dwordx4 a[96:99], v91, s[8:11], s80 offen offset:1536 nt
    s_waitcnt vmcnt(21)
    buffer_load_dwordx4 a[100:103], v91, s[8:11], s80 offen offset:1664 nt
    s_waitcnt vmcnt(21)
    buffer_load_dwordx4 a[104:107], v91, s[8:11], s80 offen offset:1792 nt
    s_waitcnt vmcnt(21)
    buffer_load_dwordx4 a[120:123], v91, s[8:11], s80 offen offset:1920 nt
    v_mov_b32 v68, 0
    v_mov_b32 v69, 0
    v_mov_b32 v70, 0
    v_mov_b32 v71, 0
    s_lshl_b32 s86, s3, 10
    s_add_u32 s86, s86, 151552
    v_add_u32 v54, s86, v2
    ds_write_b128 v54, v[68:71]
    s_waitcnt lgkmcnt(0)
    s_lshr_b32 s86, s5, 3
    s_and_b32 s87, s5, 7
    s_lshl_b32 s98, s4, 2
    s_add_u32 s98, s98, s86
    s_mul_i32 vcc_hi, s4, 36864
    s_mul_i32 s85, s86, 3840
    s_add_u32 s85, s85, vcc_hi
    s_add_u32 s85, s85, 3604480
    s_sub_u32 s62, s85, 2097152
    s_lshl_b32 s64, s86, 8
    s_add_u32 s64, s64, vcc_hi
    s_add_u32 s64, s64, 3632128
    s_lshl_b32 s63, s87, 2
    s_add_u32 s63, s63, s3
    s_lshl_b32 s63, s63, 3
    s_add_u32 s63, s63, s64
    s_mul_i32 s1, s3, 3840
    s_add_u32 s1, s1, vcc_hi
    s_add_u32 s1, s1, 3604480
    s_add_u32 s66, vcc_hi, 3619840
    s_add_u32 s72, vcc_hi, 1539072
    s_add_u32 s76, vcc_hi, 3932160
    s_lshl_b32 vcc_lo, s4, 2
    s_add_u32 vcc_lo, vcc_lo, s3
    s_mul_i32 s84, vcc_lo, 384
    s_mul_i32 vcc_lo, s5, 294912
    s_add_u32 s84, s84, vcc_lo
    s_mul_i32 s73, s4, 16640
    s_mul_i32 vcc_lo, s5, 192
    s_add_u32 s73, s73, vcc_lo
    s_lshl_b32 vcc_lo, s3, 4
    s_add_u32 s73, s73, vcc_lo
    s_add_u32 s73, s73, 2097152
    s_lshl_b32 s65, s87, 4
    s_add_u32 s65, s65, s66
    s_mul_i32 vcc_lo, s86, 3072
    s_add_u32 s65, s65, vcc_lo
    s_mul_i32 vcc_lo, s3, 768
    s_add_u32 s65, s65, vcc_lo
    s_and_b32 vcc_lo, s5, 7
    s_lshl_b32 vcc_lo, vcc_lo, 1
    v_add_u32 v13, vcc_lo, v23
    v_and_b32 v13, 15, v13
    v_lshlrev_b32 v13, 4, v13
    v_and_b32 v7, 3, v1
    v_lshl_add_u32 v7, v7, 10, v16
    v_add_u32 v7, 151552, v7
    s_mul_i32 vcc_lo, s3, 1280
    s_add_u32 vcc_lo, vcc_lo, 151552
    v_and_b32 v8, 0xf0, v17
    v_add_u32 v8, vcc_lo, v8
    s_mul_i32 s86, s6, 3277
    s_lshr_b32 s86, s86, 16
    s_mul_i32 s87, s86, 20
    s_sub_u32 s87, s6, s87
    s_lshl_b32 vcc_lo, s86, 11
    s_add_u32 s66, s66, vcc_lo
    s_lshl_b32 s67, s87, 14
    s_mul_i32 vcc_lo, s4, 768
    s_add_u32 s67, s67, vcc_lo
    s_lshl_b32 vcc_lo, s86, 7
    s_add_u32 s67, s67, vcc_lo
    s_add_u32 s67, s67, 2228224
    s_lshl_b32 s68, s0, 14
    s_add_u32 s68, s68, 2228224
    s_lshr_b32 vcc_lo, s4, 2
    s_lshl_b32 vcc_lo, vcc_lo, 13
    s_add_u32 s68, s68, vcc_lo
    s_add_u32 s74, vcc_lo, 2097152
    s_lshl_b32 s69, s0, 6
    s_add_u32 s69, s69, s72
    s_add_u32 s69, s69, 2097152
    s_lshl_b32 s71, s0, 3
    s_add_u32 s71, s71, s72
    s_add_u32 s71, s71, 2098432
    s_mul_i32 vcc_lo, s3, 1536
    s_add_u32 s74, s74, vcc_lo
    s_lshr_b32 s86, s5, 2
    s_and_b32 s87, s5, 3
    s_lshl_b32 s75, s87, 8
    s_add_u32 s75, s75, s76
    s_lshr_b32 vcc_lo, s86, 2
    s_lshl_b32 vcc_lo, vcc_lo, 10
    s_add_u32 s75, s75, vcc_lo
    s_and_b32 vcc_lo, s86, 3
    s_lshl_b32 vcc_lo, vcc_lo, 2
    s_add_u32 s75, s75, vcc_lo
    s_sub_u32 s82, s76, 32768
    s_lshl_b32 s81, s86, 11
    s_add_u32 s81, s81, s82
    s_lshl_b32 vcc_lo, s87, 8
    s_add_u32 s81, s81, vcc_lo
    s_lshr_b32 s86, s3, 1
    s_and_b32 s87, s3, 1
    s_and_b32 s98, s5, 1
    s_lshl_b32 vcc_lo, s86, 14
    s_add_u32 s81, s81, vcc_lo
    s_add_u32 s82, s82, vcc_lo
    s_lshl_b32 vcc_lo, s87, 7
    s_add_u32 s81, s81, vcc_lo
    s_add_u32 s75, s75, vcc_lo
    s_lshl_b32 vcc_lo, s86, 11
    s_add_u32 s75, s75, vcc_lo
    s_add_u32 s76, s76, vcc_lo
    s_lshl_b32 vcc_lo, s87, 12
    s_add_u32 s82, s82, vcc_lo
    s_lshl_b32 vcc_lo, s98, 13
    s_add_u32 s82, s82, vcc_lo
    s_lshl_b32 vcc_lo, s98, 10
    s_add_u32 s76, s76, vcc_lo
    s_lshl_b32 s86, s4, 3
    s_lshl_b32 s98, s98, 2
    s_add_u32 s86, s86, s98
    s_add_u32 s86, s86, s3
    s_mul_i32 s77, s86, 98304
    s_lshr_b32 s86, s5, 1
    s_mul_i32 s86, s86, 96
    s_add_u32 s77, s77, s86
    v_and_b32 v54, 8, v1
    v_mul_u32_u24 v54, 1008, v54
    v_add_u32 v54, v54, v2
    s_mov_b64 exec, 0xffff
    buffer_store_dwordx4 v[64:67], v54, s[56:59], s67 offen sc1
    s_mov_b64 exec, -1
    s_mul_i32 s86, s3, 6144
    s_add_u32 s79, s79, s86
    s_waitcnt vmcnt(8)
    v_lshlrev_b32 v19, 16, v19
    v_mov_b32 v52, 0
    v_mov_b32 v53, 0
    v_lshlrev_b32 v54, 16, v56
    v_and_b32 v55, 0xffff0000, v56
    v_add_f32 v52, v52, v54
    v_fmac_f32 v53, v54, v54
    v_add_f32 v52, v52, v55
    v_fmac_f32 v53, v55, v55
    v_lshlrev_b32 v54, 16, v57
    v_and_b32 v55, 0xffff0000, v57
    v_add_f32 v52, v52, v54
    v_fmac_f32 v53, v54, v54
    v_add_f32 v52, v52, v55
    v_fmac_f32 v53, v55, v55
    v_lshlrev_b32 v54, 16, v58
    v_and_b32 v55, 0xffff0000, v58
    v_add_f32 v52, v52, v54
    v_fmac_f32 v53, v54, v54
    v_add_f32 v52, v52, v55
    v_fmac_f32 v53, v55, v55
    v_lshlrev_b32 v54, 16, v59
    v_and_b32 v55, 0xffff0000, v59
    v_add_f32 v52, v52, v54
    v_fmac_f32 v53, v54, v54
    v_add_f32 v52, v52, v55
    v_fmac_f32 v53, v55, v55
    v_lshlrev_b32 v54, 16, v60
    v_and_b32 v55, 0xffff0000, v60
    v_add_f32 v52, v52, v54
    v_fmac_f32 v53, v54, v54
    v_add_f32 v52, v52, v55
    v_fmac_f32 v53, v55, v55
    v_lshlrev_b32 v54, 16, v61
    v_and_b32 v55, 0xffff0000, v61
    v_add_f32 v52, v52, v54
    v_fmac_f32 v53, v54, v54
    v_add_f32 v52, v52, v55
    v_fmac_f32 v53, v55, v55
    v_lshlrev_b32 v54, 16, v62
    v_and_b32 v55, 0xffff0000, v62
    v_add_f32 v52, v52, v54
    v_fmac_f32 v53, v54, v54
    v_add_f32 v52, v52, v55
    v_fmac_f32 v53, v55, v55
    v_lshlrev_b32 v54, 16, v63
    v_and_b32 v55, 0xffff0000, v63
    v_add_f32 v52, v52, v54
    v_fmac_f32 v53, v54, v54
    v_add_f32 v52, v52, v55
    v_fmac_f32 v53, v55, v55
    s_barrier
    v_xor_b32 v54, 32, v9
    ds_read_b64_tr_b16 v[56:57], v9 offset:0
    ds_read_b64_tr_b16 v[58:59], v9 offset:1024
    ds_read_b64_tr_b16 v[60:61], v54 offset:0
    ds_read_b64_tr_b16 v[62:63], v54 offset:1024
    ds_read_b64_tr_b16 v[64:65], v9 offset:8192
    ds_read_b64_tr_b16 v[66:67], v9 offset:9216
    ds_read_b64_tr_b16 v[68:69], v54 offset:8192
    ds_read_b64_tr_b16 v[70:71], v54 offset:9216
    ds_read_b64_tr_b16 v[72:73], v9 offset:16384
    ds_read_b64_tr_b16 v[74:75], v9 offset:17408
    ds_read_b64_tr_b16 v[76:77], v54 offset:16384
    ds_read_b64_tr_b16 v[78:79], v54 offset:17408
    ds_read_b64_tr_b16 v[80:81], v9 offset:24576
    ds_read_b64_tr_b16 v[82:83], v9 offset:25600
    ds_read_b64_tr_b16 v[84:85], v54 offset:24576
    ds_read_b64_tr_b16 v[86:87], v54 offset:25600
    v_add_f32_dpp v52, v52, v52 row_ror:8 row_mask:0xf bank_mask:0xf
    v_add_f32_dpp v53, v53, v53 row_ror:8 row_mask:0xf bank_mask:0xf
    s_nop 0
    v_add_f32_dpp v52, v52, v52 row_ror:4 row_mask:0xf bank_mask:0xf
    v_add_f32_dpp v53, v53, v53 row_ror:4 row_mask:0xf bank_mask:0xf
    s_nop 0
    v_add_f32_dpp v52, v52, v52 row_ror:2 row_mask:0xf bank_mask:0xf
    v_add_f32_dpp v53, v53, v53 row_ror:2 row_mask:0xf bank_mask:0xf
    s_nop 0
    v_add_f32_dpp v52, v52, v52 row_ror:1 row_mask:0xf bank_mask:0xf
    v_add_f32_dpp v53, v53, v53 row_ror:1 row_mask:0xf bank_mask:0xf
    v_mov_b32 v54, v52
    s_nop 1
    v_permlane16_swap_b32 v52, v54
    v_add_f32 v52, v52, v54
    v_mov_b32 v55, v53
    s_nop 1
    v_permlane16_swap_b32 v53, v55
    v_add_f32 v53, v53, v55
    v_mov_b32 v54, v52
    s_nop 1
    v_permlane32_swap_b32 v52, v54
    v_add_f32 v52, v52, v54
    v_mov_b32 v55, v53
    s_nop 1
    v_permlane32_swap_b32 v53, v55
    v_add_f32 v53, v53, v55
    v_mul_f32 v52, 0x3acccccd, v52
    v_mul_f32 v53, 0x3acccccd, v53
    v_fma_f32 v53, -v52, v52, v53
    s_mov_b32 s86, 0x3727c5ac
    v_add_f32 v53, s86, abs(v53)
    v_rsq_f32 v53, v53
    s_waitcnt lgkmcnt(0)
    v_mfma_f32_16x16x32_bf16 v[44:47], v[24:27], v[56:59], 0
    v_mfma_f32_16x16x32_bf16 v[48:51], v[24:27], v[60:63], 0
    v_mfma_f32_16x16x32_bf16 v[44:47], v[28:31], v[64:67], v[44:47]
    v_mfma_f32_16x16x32_bf16 v[48:51], v[28:31], v[68:71], v[48:51]
    v_mfma_f32_16x16x32_bf16 v[44:47], v[32:35], v[72:75], v[44:47]
    v_mfma_f32_16x16x32_bf16 v[48:51], v[32:35], v[76:79], v[48:51]
    v_mfma_f32_16x16x32_bf16 v[44:47], v[36:39], v[80:83], v[44:47]
    v_mfma_f32_16x16x32_bf16 v[48:51], v[36:39], v[84:87], v[48:51]
    s_nop 6
    v_fma_f32 v54, -v52, v45, v44
    v_fma_f32 v55, -v52, v49, v48
    v_mul_f32 v54, v54, v53
    v_mul_f32 v55, v55, v53
    s_nop 1
    v_permlane16_swap_b32 v54, v55
    s_mov_b32 exec_hi, 0
    s_sub_u32 s86, s61, 2097152
    buffer_store_dword v54, v17, s[56:59], s86 offen sc1
    s_mov_b64 exec, -1
    s_add_u32 s70, s70, s72
    s_add_u32 s72, s72, 1280
    buffer_load_dwordx4 a[124:127], v91, s[8:11], s80 offen offset:2048 nt
    buffer_load_dwordx4 a[128:131], v91, s[8:11], s80 offen offset:2176 nt
    buffer_load_dwordx4 a[144:147], v91, s[8:11], s80 offen offset:2304 nt
    buffer_load_dwordx4 a[148:151], v91, s[8:11], s80 offen offset:2432 nt
    s_mov_b64 exec, 1
    buffer_load_dwordx4 v[24:27], v2, s[52:55], 0 offen offset:192 sc1
    s_mov_b64 exec, -1
    buffer_load_dwordx4 a[152:155], v91, s[8:11], s80 offen offset:2560 nt
    buffer_load_dwordx4 a[168:171], v91, s[8:11], s80 offen offset:2688 nt
    buffer_load_dwordx4 a[172:175], v91, s[8:11], s80 offen offset:2816 nt
    buffer_load_dwordx4 a[176:179], v91, s[8:11], s80 offen offset:2944 nt
    s_add_u32 s80, s80, 6144
    s_waitcnt vmcnt(16)
    buffer_load_dwordx4 a[12:15], v91, s[8:11], s80 offen offset:0 nt
    s_waitcnt vmcnt(16)
    buffer_load_dwordx4 a[16:19], v91, s[8:11], s80 offen offset:128 nt
    s_waitcnt vmcnt(16)
    buffer_load_dwordx4 a[20:23], v91, s[8:11], s80 offen offset:256 nt
    s_waitcnt vmcnt(16)
    buffer_load_dwordx4 a[36:39], v91, s[8:11], s80 offen offset:384 nt
    s_waitcnt vmcnt(16)
    buffer_load_dwordx4 a[40:43], v91, s[8:11], s80 offen offset:512 nt
    s_waitcnt vmcnt(16)
    buffer_load_dwordx4 a[44:47], v91, s[8:11], s80 offen offset:640 nt
    s_waitcnt vmcnt(14)
    buffer_load_dwordx4 a[60:63], v91, s[8:11], s80 offen offset:768 nt
    s_waitcnt vmcnt(14)
    buffer_load_dwordx4 a[64:67], v91, s[8:11], s80 offen offset:896 nt
    s_waitcnt vmcnt(14)
    buffer_load_dwordx4 a[68:71], v91, s[8:11], s80 offen offset:1024 nt
    s_mul_i32 s86, s3, 6144
    v_add_u32 v86, s86, v2
    v_lshrrev_b32 v87, 4, v1
    v_bfe_u32 v54, v1, 2, 2
    v_lshl_add_u32 v87, v87, 3, v54
    v_mul_u32_u24 v87, 384, v87
    v_and_b32 v54, 3, v1
    v_lshl_add_u32 v87, v54, 3, v87
    s_mul_i32 s86, s3, 96
    v_add_u32 v87, s86, v87
    s_waitcnt vmcnt(13)
    s_barrier
    s_mov_b64 exec, 1
m1_go_chk:
    v_and_b32 v24, v24, v25
    v_and_b32 v26, v26, v27
    v_and_b32 v24, v24, v26
    v_cmp_ne_u32 vcc, -1, v24
    s_cbranch_vccnz m1_go_slow
m1_go_ok:
    s_cmp_lg_u32 s3, 0
    s_nop 2
    s_cbranch_scc1 m1_noclaim
    s_and_b32 s86, s2, 7
    s_lshl_b32 s86, 1, s86
    v_mov_b32 v24, s86
    s_lshl_b32 s86, s2, 5
    s_add_u32 s86, s86, 524288
    buffer_store_dword v24, v2, s[56:59], s86 offen sc1
m1_noclaim:
    s_mov_b64 exec, -1
    buffer_load_dwordx4 a[84:87], v91, s[8:11], s80 offen offset:1152 nt
    s_waitcnt vmcnt(13)
    buffer_load_dwordx4 a[88:91], v91, s[8:11], s80 offen offset:1280 nt
    s_waitcnt vmcnt(13)
    buffer_load_dwordx4 a[92:95], v91, s[8:11], s80 offen offset:1408 nt
    s_waitcnt vmcnt(13)
    buffer_load_dwordx4 a[108:111], v91, s[8:11], s80 offen offset:1536 nt
    s_waitcnt vmcnt(13)
    buffer_load_dwordx4 a[112:115], v91, s[8:11], s80 offen offset:1664 nt
    s_waitcnt vmcnt(13)
    buffer_load_dwordx4 a[116:119], v91, s[8:11], s80 offen offset:1792 nt
    s_waitcnt vmcnt(13)
    buffer_load_dwordx4 a[132:135], v91, s[8:11], s80 offen offset:1920 nt
    s_waitcnt vmcnt(13)
    buffer_load_dwordx4 a[136:139], v91, s[8:11], s80 offen offset:2048 nt
    s_waitcnt vmcnt(13)
    buffer_load_dwordx4 a[140:143], v91, s[8:11], s80 offen offset:2176 nt
    s_waitcnt vmcnt(13)
    buffer_load_dwordx4 a[156:159], v91, s[8:11], s80 offen offset:2304 nt
    s_waitcnt vmcnt(13)
    buffer_load_dwordx4 a[160:163], v91, s[8:11], s80 offen offset:2432 nt
    s_waitcnt vmcnt(13)
    buffer_load_dwordx4 a[164:167], v91, s[8:11], s80 offen offset:2560 nt
    s_waitcnt vmcnt(13)
    buffer_load_dwordx4 a[180:183], v91, s[8:11], s80 offen offset:2688 nt
    s_waitcnt vmcnt(13)
    buffer_load_dwordx4 a[184:187], v91, s[8:11], s80 offen offset:2816 nt
    s_waitcnt vmcnt(13)
    buffer_load_dwordx4 a[188:191], v91, s[8:11], s80 offen offset:2944 nt
    s_mul_i32 s86, s6, 3277
    s_lshr_b32 s86, s86, 16
    s_mul_i32 s87, s86, 20
    s_sub_u32 s87, s6, s87
    s_mul_i32 s80, s4, 983040
    s_mul_i32 s86, s86, 163840
    s_add_u32 s80, s80, s86
    s_lshl_b32 s87, s87, 6
    s_add_u32 s80, s80, s87
    s_waitcnt vmcnt(13)
    buffer_load_dwordx4 v[92:95], v2, s[12:15], s79 offen offset:0 nt
    s_waitcnt vmcnt(13)
    buffer_load_dwordx4 v[96:99], v2, s[12:15], s79 offen offset:1024 nt
    s_waitcnt vmcnt(13)
    buffer_load_dwordx4 v[100:103], v2, s[12:15], s79 offen offset:2048 nt
    s_waitcnt vmcnt(13)
    buffer_load_dwordx4 v[104:107], v2, s[12:15], s79 offen offset:3072 nt
    s_add_u32 s79, s79, 4096
    s_waitcnt vmcnt(13)
    buffer_load_dwordx4 v[108:111], v2, s[12:15], s79 offen offset:0 nt
    s_waitcnt vmcnt(13)
    buffer_load_dwordx4 v[112:115], v2, s[12:15], s79 offen offset:1024 nt
    v_lshlrev_b32 v36, 5, v1
    s_mov_b32 s86, 524288
    buffer_load_dword v88, v36, s[56:59], s86 offen sc1
    s_add_u32 s86, s86, 2048
    buffer_load_dword v89, v36, s[56:59], s86 offen sc1
    s_add_u32 s86, s86, 2048
    buffer_load_dword v90, v36, s[56:59], s86 offen sc1
    s_add_u32 s86, s86, 2048
    buffer_load_dword v91, v36, s[56:59], s86 offen sc1
    s_add_u32 s79, s79, 20480
    s_waitcnt vmcnt(17)
    buffer_load_dwordx4 v[116:119], v2, s[12:15], s79 offen offset:0 nt
    s_waitcnt vmcnt(17)
    buffer_load_dwordx4 v[120:123], v2, s[12:15], s79 offen offset:1024 nt
    s_waitcnt vmcnt(17)
    buffer_load_dwordx4 v[124:127], v2, s[12:15], s79 offen offset:2048 nt
    s_waitcnt vmcnt(17)
    buffer_load_dwordx4 v[128:131], v2, s[12:15], s79 offen offset:3072 nt
    s_add_u32 s79, s79, 4096
    s_waitcnt vmcnt(17)
    buffer_load_dwordx4 v[132:135], v2, s[12:15], s79 offen offset:0 nt
    s_waitcnt vmcnt(17)
    buffer_load_dwordx4 v[136:139], v2, s[12:15], s79 offen offset:1024 nt
    s_add_u32 s79, s79, 20480
    s_waitcnt vmcnt(17)
    buffer_load_dwordx4 v[140:143], v2, s[12:15], s79 offen offset:0 nt
    s_waitcnt vmcnt(17)
    buffer_load_dwordx4 v[144:147], v2, s[12:15], s79 offen offset:1024 nt
    s_waitcnt vmcnt(17)
    buffer_load_dwordx4 v[148:151], v2, s[12:15], s79 offen offset:2048 nt
    s_waitcnt vmcnt(17)
    buffer_load_dwordx4 v[152:155], v2, s[12:15], s79 offen offset:3072 nt
    s_add_u32 s79, s79, 4096
    s_waitcnt vmcnt(17)
    buffer_load_dwordx4 v[156:159], v2, s[12:15], s79 offen offset:0 nt
    s_waitcnt vmcnt(17)
    buffer_load_dwordx4 v[160:163], v2, s[12:15], s79 offen offset:1024 nt
    s_waitcnt vmcnt(12)
m1_bar_chk:
    v_and_b32 v40, 0xff, v88
    v_and_b32 v41, 0xff, v89
    v_and_b32 v42, 0xff, v90
    v_and_b32 v43, 0xff, v91
    v_add_u32_dpp v40, v40, v40 quad_perm:[1,0,3,2] row_mask:0xf bank_mask:0xf
    v_add_u32_dpp v41, v41, v41 quad_perm:[1,0,3,2] row_mask:0xf bank_mask:0xf
    v_add_u32_dpp v42, v42, v42 quad_perm:[1,0,3,2] row_mask:0xf bank_mask:0xf
    v_add_u32_dpp v43, v43, v43 quad_perm:[1,0,3,2] row_mask:0xf bank_mask:0xf
    v_add_u32_dpp v40, v40, v40 quad_perm:[2,3,0,1] row_mask:0xf bank_mask:0xf
    v_add_u32_dpp v41, v41, v41 quad_perm:[2,3,0,1] row_mask:0xf bank_mask:0xf
    v_add_u32_dpp v42, v42, v42 quad_perm:[2,3,0,1] row_mask:0xf bank_mask:0xf
    v_add_u32_dpp v43, v43, v43 quad_perm:[2,3,0,1] row_mask:0xf bank_mask:0xf
    v_add_u32_dpp v40, v40, v40 row_half_mirror row_mask:0xf bank_mask:0xf
    v_add_u32_dpp v41, v41, v41 row_half_mirror row_mask:0xf bank_mask:0xf
    v_add_u32_dpp v42, v42, v42 row_half_mirror row_mask:0xf bank_mask:0xf
    v_add_u32_dpp v43, v43, v43 row_half_mirror row_mask:0xf bank_mask:0xf
    v_mov_b32 v39, 0xff
    v_xor_b32 v40, v40, v39
    v_xor_b32 v41, v41, v39
    v_xor_b32 v42, v42, v39
    v_xor_b32 v43, v43, v39
    v_or3_b32 v40, v40, v41, v42
    v_or_b32 v40, v40, v43
    v_max3_u32 v41, v88, v89, v90
    v_max_u32 v41, v41, v91
    v_cmp_eq_u32 s[100:101], -1, v41
    v_cmp_ne_u32 vcc, 0, v40
    s_or_b64 vcc, vcc, s[100:101]
    s_cbranch_scc1 m1_bar_slow
m1_bar_ok:
    s_mov_b32 s100, 0x00020002
    s_mov_b32 s101, 0x00020002
    s_mov_b32 s10, 0
    s_mov_b32 exec_lo, -1
    s_mov_b32 exec_hi, 0xffff
    buffer_load_dwordx4 v[24:27], v2, s[56:59], s62 offen offset:0 sc1
    buffer_load_dwordx4 v[28:31], v2, s[56:59], s62 offen offset:768 sc1
    buffer_load_dwordx4 v[32:35], v2, s[56:59], s62 offen offset:1536 sc1
    buffer_load_dwordx4 v[36:39], v2, s[56:59], s62 offen offset:2304 sc1
    buffer_load_dwordx4 v[40:43], v2, s[56:59], s62 offen offset:3072 sc1
    s_mov_b64 exec, -1
    s_lshr_b32 s86, s5, 4
    s_mul_i32 s86, s86, 2097152
    s_and_b32 s87, s5, 15
    s_lshl_b32 s87, s87, 2
    s_add_u32 s87, s87, s3
    s_mul_i32 s87, s87, 576
    s_add_u32 s86, s86, s87
    s_mul_i32 s87, s4, 36864
    s_add_u32 s86, s86, s87
    s_add_u32 s86, s86, 3604480
    s_lshl_b32 s87, s3, 11
    s_add_u32 m0, s87, 156672
    v_lshlrev_b32 v89, 6, v1
    s_mov_b64 exec, 0x1ff
    buffer_load_dword v89, s[56:59], s86 offen sc1 lds
    s_mov_b64 exec, -1
    ds_write_b128 v86, v[92:95] offset:0
    ds_write_b128 v86, v[96:99] offset:1024
    ds_write_b128 v86, v[100:103] offset:2048
    ds_write_b128 v86, v[104:107] offset:3072
    ds_write_b128 v86, v[108:111] offset:4096
    ds_write_b128 v86, v[112:115] offset:5120
    s_waitcnt lgkmcnt(0)
    s_barrier
    ds_read_b64_tr_b16 v[92:93], v87 offset:0
    ds_read_b64_tr_b16 v[94:95], v87 offset:1536
    ds_read_b64_tr_b16 v[96:97], v87 offset:32
    ds_read_b64_tr_b16 v[98:99], v87 offset:1568
    ds_read_b64_tr_b16 v[100:101], v87 offset:64
    ds_read_b64_tr_b16 v[102:103], v87 offset:1600
    ds_read_b64_tr_b16 v[104:105], v87 offset:12288
    ds_read_b64_tr_b16 v[106:107], v87 offset:13824
    ds_read_b64_tr_b16 v[108:109], v87 offset:12320
    ds_read_b64_tr_b16 v[110:111], v87 offset:13856
    ds_read_b64_tr_b16 v[112:113], v87 offset:12352
    ds_read_b64_tr_b16 v[114:115], v87 offset:13888
    s_add_u32 s79, s79, 20480
    buffer_load_dwordx4 v[164:167], v2, s[12:15], s79 offen offset:0 nt
    buffer_load_dwordx4 v[168:171], v2, s[12:15], s79 offen offset:1024 nt
    s_waitcnt vmcnt(19)
    buffer_load_dwordx4 v[172:175], v2, s[12:15], s79 offen offset:2048 nt
    s_waitcnt vmcnt(19)
    buffer_load_dwordx4 v[176:179], v2, s[12:15], s79 offen offset:3072 nt
    s_add_u32 s79, s79, 4096
    s_waitcnt vmcnt(19)
    buffer_load_dwordx4 v[180:183], v2, s[12:15], s79 offen offset:0 nt
    s_waitcnt vmcnt(19)
    buffer_load_dwordx4 v[184:187], v2, s[12:15], s79 offen offset:1024 nt
    s_waitcnt vmcnt(18)
    ds_write_b128 v86, v[116:119] offset:24576
    ds_write_b128 v86, v[120:123] offset:25600
    ds_write_b128 v86, v[124:127] offset:26624
    ds_write_b128 v86, v[128:131] offset:27648
    ds_write_b128 v86, v[132:135] offset:28672
    ds_write_b128 v86, v[136:139] offset:29696
    s_waitcnt lgkmcnt(0)
    s_barrier
    ds_read_b64_tr_b16 v[116:117], v87 offset:24576
    ds_read_b64_tr_b16 v[118:119], v87 offset:26112
    ds_read_b64_tr_b16 v[120:121], v87 offset:24608
    ds_read_b64_tr_b16 v[122:123], v87 offset:26144
    ds_read_b64_tr_b16 v[124:125], v87 offset:24640
    ds_read_b64_tr_b16 v[126:127], v87 offset:26176
    ds_read_b64_tr_b16 v[128:129], v87 offset:36864
    ds_read_b64_tr_b16 v[130:131], v87 offset:38400
    ds_read_b64_tr_b16 v[132:133], v87 offset:36896
    ds_read_b64_tr_b16 v[134:135], v87 offset:38432
    ds_read_b64_tr_b16 v[136:137], v87 offset:36928
    ds_read_b64_tr_b16 v[138:139], v87 offset:38464
    s_add_u32 s79, s79, 20480
    buffer_load_dwordx4 v[188:191], v2, s[12:15], s79 offen offset:0 nt
    buffer_load_dwordx4 v[192:195], v2, s[12:15], s79 offen offset:1024 nt
    s_waitcnt vmcnt(19)
    buffer_load_dwordx4 v[196:199], v2, s[12:15], s79 offen offset:2048 nt
    s_waitcnt vmcnt(19)
    buffer_load_dwordx4 v[200:203], v2, s[12:15], s79 offen offset:3072 nt
    s_add_u32 s79, s79, 4096
    s_waitcnt vmcnt(19)
    buffer_load_dwordx4 v[204:207], v2, s[12:15], s79 offen offset:0 nt
    s_waitcnt vmcnt(19)
    buffer_load_dwordx4 v[208:211], v2, s[12:15], s79 offen offset:1024 nt
    s_waitcnt vmcnt(13)
    s_mov_b32 exec_hi, 0xffff
    v_pk_add_f32 v[44:45], v[24:25], v[28:29]
    v_pk_add_f32 v[46:47], v[26:27], v[30:31]
    v_pk_add_f32 v[44:45], v[44:45], v[32:33]
    v_pk_add_f32 v[46:47], v[46:47], v[34:35]
    v_pk_add_f32 v[44:45], v[44:45], v[36:37]
    v_pk_add_f32 v[46:47], v[46:47], v[38:39]
    v_pk_add_f32 v[44:45], v[44:45], v[40:41]
    v_pk_add_f32 v[46:47], v[46:47], v[42:43]
    v_cvt_pk_bf16_f32 v48, v44, v45
    v_cvt_pk_bf16_f32 v49, v46, v47
    ds_write_b64 v14, v[48:49]
    s_mov_b64 exec, -1
    ds_read_b128 v[32:35], v5 offset:0
    ds_read_b128 v[36:39], v5 offset:128
    ds_read_b128 v[40:43], v5 offset:256
    ds_read_b128 v[44:47], v6 offset:0
    ds_read_b128 v[48:51], v6 offset:128
    ds_read_b128 v[52:55], v6 offset:256
    s_branch m1_QK
m1_stream2:
    ds_write_b128 v86, v[140:143] offset:0
    ds_write_b128 v86, v[144:147] offset:1024
    ds_write_b128 v86, v[148:151] offset:2048
    ds_write_b128 v86, v[152:155] offset:3072
    ds_write_b128 v86, v[156:159] offset:4096
    ds_write_b128 v86, v[160:163] offset:5120
    s_waitcnt lgkmcnt(0)
    s_barrier
    ds_read_b64_tr_b16 v[140:141], v87 offset:0
    ds_read_b64_tr_b16 v[142:143], v87 offset:1536
    ds_read_b64_tr_b16 v[144:145], v87 offset:32
    ds_read_b64_tr_b16 v[146:147], v87 offset:1568
    ds_read_b64_tr_b16 v[148:149], v87 offset:64
    ds_read_b64_tr_b16 v[150:151], v87 offset:1600
    ds_read_b64_tr_b16 v[152:153], v87 offset:12288
    ds_read_b64_tr_b16 v[154:155], v87 offset:13824
    ds_read_b64_tr_b16 v[156:157], v87 offset:12320
    ds_read_b64_tr_b16 v[158:159], v87 offset:13856
    ds_read_b64_tr_b16 v[160:161], v87 offset:12352
    ds_read_b64_tr_b16 v[162:163], v87 offset:13888
    s_add_u32 s79, s79, 20480
    buffer_load_dwordx4 v[212:215], v2, s[12:15], s79 offen offset:0 nt
    buffer_load_dwordx4 v[216:219], v2, s[12:15], s79 offen offset:1024 nt
    s_waitcnt vmcnt(14)
    buffer_load_dwordx4 v[220:223], v2, s[12:15], s79 offen offset:2048 nt
    s_waitcnt vmcnt(14)
    buffer_load_dwordx4 v[224:227], v2, s[12:15], s79 offen offset:3072 nt
    s_add_u32 s79, s79, 4096
    s_waitcnt vmcnt(14)
    buffer_load_dwordx4 v[228:231], v2, s[12:15], s79 offen offset:0 nt
    s_waitcnt vmcnt(14)
    buffer_load_dwordx4 v[232:235], v2, s[12:15], s79 offen offset:1024 nt
    s_waitcnt vmcnt(13)
    ds_write_b128 v86, v[164:167] offset:24576
    ds_write_b128 v86, v[168:171] offset:25600
    ds_write_b128 v86, v[172:175] offset:26624
    ds_write_b128 v86, v[176:179] offset:27648
    ds_write_b128 v86, v[180:183] offset:28672
    ds_write_b128 v86, v[184:187] offset:29696
    s_waitcnt lgkmcnt(0)
    s_barrier
    ds_read_b64_tr_b16 v[164:165], v87 offset:24576
    ds_read_b64_tr_b16 v[166:167], v87 offset:26112
    ds_read_b64_tr_b16 v[168:169], v87 offset:24608
    ds_read_b64_tr_b16 v[170:171], v87 offset:26144
    ds_read_b64_tr_b16 v[172:173], v87 offset:24640
    ds_read_b64_tr_b16 v[174:175], v87 offset:26176
    ds_read_b64_tr_b16 v[176:177], v87 offset:36864
    ds_read_b64_tr_b16 v[178:179], v87 offset:38400
    ds_read_b64_tr_b16 v[180:181], v87 offset:36896
    ds_read_b64_tr_b16 v[182:183], v87 offset:38432
    ds_read_b64_tr_b16 v[184:185], v87 offset:36928
    ds_read_b64_tr_b16 v[186:187], v87 offset:38464
    s_add_u32 s79, s79, 20480
    buffer_load_dwordx4 v[236:239], v2, s[12:15], s79 offen offset:0 nt
    buffer_load_dwordx4 v[240:243], v2, s[12:15], s79 offen offset:1024 nt
    s_waitcnt vmcnt(14)
    buffer_load_dwordx4 v[244:247], v2, s[12:15], s79 offen offset:2048 nt
    s_waitcnt vmcnt(14)
    buffer_load_dwordx4 v[248:251], v2, s[12:15], s79 offen offset:3072 nt
    s_add_u32 s79, s79, 4096
    s_waitcnt vmcnt(14)
    buffer_load_dwordx4 v[252:255], v2, s[12:15], s79 offen offset:0 nt
    s_waitcnt vmcnt(14)
    buffer_load_dwordx4 a[228:231], v2, s[12:15], s79 offen offset:1024 nt
    s_waitcnt vmcnt(13)
    ds_write_b128 v86, v[188:191] offset:0
    ds_write_b128 v86, v[192:195] offset:1024
    ds_write_b128 v86, v[196:199] offset:2048
    ds_write_b128 v86, v[200:203] offset:3072
    ds_write_b128 v86, v[204:207] offset:4096
    ds_write_b128 v86, v[208:211] offset:5120
    s_waitcnt lgkmcnt(0)
    s_barrier
    ds_read_b64_tr_b16 v[188:189], v87 offset:0
    ds_read_b64_tr_b16 v[190:191], v87 offset:1536
    ds_read_b64_tr_b16 v[192:193], v87 offset:32
    ds_read_b64_tr_b16 v[194:195], v87 offset:1568
    ds_read_b64_tr_b16 v[196:197], v87 offset:64
    ds_read_b64_tr_b16 v[198:199], v87 offset:1600
    ds_read_b64_tr_b16 v[200:201], v87 offset:12288
    ds_read_b64_tr_b16 v[202:203], v87 offset:13824
    ds_read_b64_tr_b16 v[204:205], v87 offset:12320
    ds_read_b64_tr_b16 v[206:207], v87 offset:13856
    ds_read_b64_tr_b16 v[208:209], v87 offset:12352
    ds_read_b64_tr_b16 v[210:211], v87 offset:13888
    s_add_u32 s79, s79, 20480
    buffer_load_dwordx4 a[232:235], v2, s[12:15], s79 offen offset:0 nt
    buffer_load_dwordx4 a[236:239], v2, s[12:15], s79 offen offset:1024 nt
    s_waitcnt vmcnt(13)
    buffer_load_dwordx4 a[240:243], v2, s[12:15], s79 offen offset:2048 nt
    s_waitcnt vmcnt(13)
    buffer_load_dwordx4 a[244:247], v2, s[12:15], s79 offen offset:3072 nt
    s_add_u32 s79, s79, 4096
    s_waitcnt vmcnt(13)
    buffer_load_dwordx4 a[248:251], v2, s[12:15], s79 offen offset:0 nt
    s_waitcnt vmcnt(13)
    buffer_load_dwordx4 a[252:255], v2, s[12:15], s79 offen offset:1024 nt
    v_mov_b32 v40, -1
    v_mov_b32 v41, -1
    v_mov_b32 v42, -1
    v_mov_b32 v43, -1
    s_lshr_b32 s86, s5, 4
    s_mul_i32 s86, s86, 294912
    s_and_b32 s87, s5, 15
    s_lshl_b32 s87, s87, 2
    s_add_u32 s87, s87, s3
    s_mul_i32 s87, s87, 576
    s_add_u32 s86, s86, s87
    s_mul_i32 s87, s4, 36864
    s_add_u32 s86, s86, s87
    s_add_u32 s86, s86, 5701632
    s_mov_b32 exec_hi, 0xf
    buffer_store_dwordx4 v[40:43], v2, s[56:59], s86 offen sc1
    s_and_b32 s87, s5, 15
    s_lshl_b32 s87, s87, 2
    s_add_u32 s87, s87, s3
    s_mul_i32 s87, s87, 96
    s_lshr_b32 s98, s5, 4
    s_lshl_b32 s98, s98, 13
    s_add_u32 s87, s87, s98
    s_mul_i32 s98, s4, 16640
    s_add_u32 s87, s87, s98
    s_add_u32 s87, s87, 4194304
    s_mov_b64 exec, 0x3f
    buffer_store_dwordx4 v[40:43], v2, s[56:59], s87 offen sc1
    s_mov_b64 exec, -1
    buffer_load_dwordx4 v[36:39], v13, s[56:59], s64 offen sc1
    s_waitcnt vmcnt(15)
    ds_write_b128 v86, v[212:215] offset:24576
    ds_write_b128 v86, v[216:219] offset:25600
    ds_write_b128 v86, v[220:223] offset:26624
    ds_write_b128 v86, v[224:227] offset:27648
    ds_write_b128 v86, v[228:231] offset:28672
    ds_write_b128 v86, v[232:235] offset:29696
    s_waitcnt lgkmcnt(0)
    s_barrier
    ds_read_b64_tr_b16 v[212:213], v87 offset:24576
    ds_read_b64_tr_b16 v[214:215], v87 offset:26112
    ds_read_b64_tr_b16 v[216:217], v87 offset:24608
    ds_read_b64_tr_b16 v[218:219], v87 offset:26144
    ds_read_b64_tr_b16 v[220:221], v87 offset:24640
    ds_read_b64_tr_b16 v[222:223], v87 offset:26176
    ds_read_b64_tr_b16 v[224:225], v87 offset:36864
    ds_read_b64_tr_b16 v[226:227], v87 offset:38400
    ds_read_b64_tr_b16 v[228:229], v87 offset:36896
    ds_read_b64_tr_b16 v[230:231], v87 offset:38432
    ds_read_b64_tr_b16 v[232:233], v87 offset:36928
    ds_read_b64_tr_b16 v[234:235], v87 offset:38464
    v_lshrrev_b32 v91, 4, v1
    v_mul_u32_u24 v90, 1280, v91
    v_lshlrev_b32 v91, 5, v91
    v_xor_b32 v91, v91, v2
    v_and_b32 v91, 0xf0, v91
    v_add_u32 v90, v90, v91
    v_xor_b32 v91, 128, v90
    s_mul_i32 s98, s3, 40896
    s_add_u32 s98, s98, s80
    s_lshl_b32 vcc_lo, s3, 13
    s_add_u32 m0, vcc_lo, 49152
    s_nop 0
    buffer_load_dwordx4 v90, s[20:23], s98 offen  lds
    s_add_u32 s98, s98, 5120
    s_add_u32 m0, vcc_lo, 50176
    s_nop 0
    buffer_load_dwordx4 v90, s[20:23], s98 offen  lds
    s_add_u32 s98, s98, 5120
    s_add_u32 m0, vcc_lo, 51200
    s_waitcnt vmcnt(16)
    buffer_load_dwordx4 v91, s[20:23], s98 offen  lds
    s_add_u32 s98, s98, 5120
    s_add_u32 m0, vcc_lo, 52224
    s_waitcnt vmcnt(16)
    buffer_load_dwordx4 v91, s[20:23], s98 offen  lds
    s_add_u32 s98, s98, 5120
    s_add_u32 m0, vcc_lo, 53248
    s_waitcnt vmcnt(16)
    buffer_load_dwordx4 v90, s[20:23], s98 offen  lds
    s_add_u32 s98, s98, 5120
    s_add_u32 m0, vcc_lo, 54272
    s_waitcnt vmcnt(16)
    buffer_load_dwordx4 v90, s[20:23], s98 offen  lds
    s_add_u32 s98, s98, 5120
    s_add_u32 m0, vcc_lo, 55296
    s_waitcnt vmcnt(16)
    buffer_load_dwordx4 v91, s[20:23], s98 offen  lds
    s_add_u32 s98, s98, 5120
    s_add_u32 m0, vcc_lo, 56320
    s_waitcnt vmcnt(16)
    buffer_load_dwordx4 v91, s[20:23], s98 offen  lds
    ds_write_b128 v86, v[236:239] offset:0
    ds_write_b128 v86, v[240:243] offset:1024
    ds_write_b128 v86, v[244:247] offset:2048
    ds_write_b128 v86, v[248:251] offset:3072
    ds_write_b128 v86, v[252:255] offset:4096
    ds_write_b128 v86, a[228:231] offset:5120
    s_waitcnt lgkmcnt(0)
    s_barrier
    ds_read_b64_tr_b16 v[236:237], v87 offset:0
    ds_read_b64_tr_b16 v[238:239], v87 offset:1536
    ds_read_b64_tr_b16 v[240:241], v87 offset:32
    ds_read_b64_tr_b16 v[242:243], v87 offset:1568
    ds_read_b64_tr_b16 v[244:245], v87 offset:64
    ds_read_b64_tr_b16 v[246:247], v87 offset:1600
    ds_read_b64_tr_b16 v[248:249], v87 offset:12288
    ds_read_b64_tr_b16 v[250:251], v87 offset:13824
    ds_read_b64_tr_b16 v[252:253], v87 offset:12320
    ds_read_b64_tr_b16 v[254:255], v87 offset:13856
    ds_read_b64_tr_b16 a[228:229], v87 offset:12352
    ds_read_b64_tr_b16 a[230:231], v87 offset:13888
    v_bfe_u32 v54, v1, 2, 2
    v_lshrrev_b32 v55, 5, v1
    v_lshl_add_u32 v50, v54, 2, v55
    v_lshl_add_u32 v51, v54, 1, v55
    v_mul_u32_u24 v50, 12288, v50
    v_mul_u32_u24 v51, 12288, v51
    v_and_b32 v54, 16, v1
    v_and_b32 v55, 3, v1
    v_lshlrev_b32 v54, 2, v54
    v_lshl_add_u32 v54, v55, 4, v54
    v_add_u32 v50, v50, v54
    v_add_u32 v51, v51, v54
    s_add_u32 s86, s84, 24576
    s_add_u32 s87, s84, 196608
    s_waitcnt vmcnt(16)
    buffer_load_dwordx4 a[192:195], v50, s[32:35], s84 offen offset:0 nt
    s_waitcnt vmcnt(16)
    buffer_load_dwordx4 a[196:199], v50, s[32:35], s84 offen offset:128 nt
    s_waitcnt vmcnt(16)
    buffer_load_dwordx4 a[200:203], v50, s[32:35], s84 offen offset:256 nt
    s_waitcnt vmcnt(16)
    buffer_load_dwordx4 a[204:207], v50, s[32:35], s86 offen offset:0 nt
    s_waitcnt vmcnt(16)
    buffer_load_dwordx4 a[208:211], v50, s[32:35], s86 offen offset:128 nt
    s_waitcnt vmcnt(16)
    buffer_load_dwordx4 a[212:215], v50, s[32:35], s86 offen offset:256 nt
    s_waitcnt vmcnt(13)
    buffer_load_dwordx4 a[216:219], v51, s[32:35], s87 offen offset:0 nt
    s_waitcnt vmcnt(13)
    buffer_load_dwordx4 a[220:223], v51, s[32:35], s87 offen offset:128 nt
    s_waitcnt vmcnt(13)
    buffer_load_dwordx4 a[224:227], v51, s[32:35], s87 offen offset:256 nt
    ds_write_b128 v86, a[232:235] offset:24576
    ds_write_b128 v86, a[236:239] offset:25600
    ds_write_b128 v86, a[240:243] offset:26624
    ds_write_b128 v86, a[244:247] offset:27648
    ds_write_b128 v86, a[248:251] offset:28672
    ds_write_b128 v86, a[252:255] offset:29696
    s_waitcnt lgkmcnt(0)
    s_barrier
    ds_read_b64_tr_b16 a[232:233], v87 offset:24576
    ds_read_b64_tr_b16 a[234:235], v87 offset:26112
    ds_read_b64_tr_b16 a[236:237], v87 offset:24608
    ds_read_b64_tr_b16 a[238:239], v87 offset:26144
    ds_read_b64_tr_b16 a[240:241], v87 offset:24640
    ds_read_b64_tr_b16 a[242:243], v87 offset:26176
    ds_read_b64_tr_b16 a[244:245], v87 offset:36864
    ds_read_b64_tr_b16 a[246:247], v87 offset:38400
    ds_read_b64_tr_b16 a[248:249], v87 offset:36896
    ds_read_b64_tr_b16 a[250:251], v87 offset:38432
    ds_read_b64_tr_b16 a[252:253], v87 offset:36928
    ds_read_b64_tr_b16 a[254:255], v87 offset:38464
    s_branch m1_PV
m1_stream3:
    v_add_u32 v50, 4294930432, v9
    s_waitcnt vmcnt(10)
    s_barrier
    v_xor_b32 v51, 32, v50
    ds_read_b64_tr_b16 v[56:57], v50 offset:0
    ds_read_b64_tr_b16 v[58:59], v50 offset:1024
    ds_read_b64_tr_b16 v[60:61], v51 offset:0
    ds_read_b64_tr_b16 v[62:63], v51 offset:1024
    ds_read_b64_tr_b16 v[64:65], v50 offset:8192
    ds_read_b64_tr_b16 v[66:67], v50 offset:9216
    ds_read_b64_tr_b16 v[68:69], v51 offset:8192
    ds_read_b64_tr_b16 v[70:71], v51 offset:9216
    ds_read_b64_tr_b16 v[72:73], v50 offset:16384
    ds_read_b64_tr_b16 v[74:75], v50 offset:17408
    ds_read_b64_tr_b16 v[76:77], v51 offset:16384
    ds_read_b64_tr_b16 v[78:79], v51 offset:17408
    ds_read_b64_tr_b16 v[80:81], v50 offset:24576
    ds_read_b64_tr_b16 v[82:83], v50 offset:25600
    ds_read_b64_tr_b16 v[84:85], v51 offset:24576
    ds_read_b64_tr_b16 v[86:87], v51 offset:25600
    v_and_b32 v49, 7, v1
    v_lshlrev_b32 v48, 3, v16
    v_lshl_add_u32 v48, v49, 4, v48
    s_lshl_b32 s87, s4, 5
    s_add_u32 s86, s5, s87
    s_mul_i32 s79, s86, 24576
    s_mul_i32 s86, s3, 384
    s_add_u32 s79, s79, s86
    s_waitcnt lgkmcnt(0)
    v_lshrrev_b32 v55, 4, v1
    v_mul_u32_u24 v54, 12288, v55
    v_lshlrev_b32 v55, 5, v55
    v_xor_b32 v55, v55, v2
    v_and_b32 v55, 0xf0, v55
    v_add_u32 v54, v54, v55
    v_xor_b32 v55, 128, v54
    s_mul_i32 s98, s3, 393152
    s_add_u32 s98, s98, s83
    s_lshl_b32 vcc_lo, s3, 13
    s_add_u32 m0, vcc_lo, 118784
    s_nop 0
    buffer_load_dwordx4 v54, s[28:31], s98 offen nt lds
    s_add_u32 s98, s98, 49152
    s_add_u32 m0, vcc_lo, 119808
    s_nop 0
    buffer_load_dwordx4 v54, s[28:31], s98 offen nt lds
    s_add_u32 s98, s98, 49152
    s_add_u32 m0, vcc_lo, 120832
    s_nop 0
    buffer_load_dwordx4 v55, s[28:31], s98 offen nt lds
    s_add_u32 s98, s98, 49152
    s_add_u32 m0, vcc_lo, 121856
    s_nop 0
    buffer_load_dwordx4 v55, s[28:31], s98 offen nt lds
    s_add_u32 s98, s98, 49152
    s_add_u32 m0, vcc_lo, 122880
    s_nop 0
    buffer_load_dwordx4 v54, s[28:31], s98 offen nt lds
    s_add_u32 s98, s98, 49152
    s_add_u32 m0, vcc_lo, 123904
    s_waitcnt vmcnt(14)
    buffer_load_dwordx4 v54, s[28:31], s98 offen nt lds
    s_add_u32 s98, s98, 49152
    s_add_u32 m0, vcc_lo, 124928
    s_waitcnt vmcnt(14)
    buffer_load_dwordx4 v55, s[28:31], s98 offen nt lds
    s_add_u32 s98, s98, 49152
    s_add_u32 m0, vcc_lo, 125952
    s_waitcnt vmcnt(14)
    buffer_load_dwordx4 v55, s[28:31], s98 offen nt lds
    s_mov_b32 exec_lo, 0x00ff00ff
    s_mov_b32 exec_hi, 0x00ff00ff
    buffer_load_dwordx4 v[24:27], v48, s[56:59], s66 offen offset:0 sc1
    buffer_load_dwordx4 v[28:31], v48, s[56:59], s66 offen offset:512 sc1
    buffer_load_dwordx4 v[32:35], v48, s[56:59], s66 offen offset:1024 sc1
    buffer_load_dwordx4 v[36:39], v48, s[56:59], s66 offen offset:1536 sc1
    s_mov_b64 exec, -1
    s_barrier
    v_lshrrev_b32 v54, 3, v1
    v_mul_u32_u24 v54, 1536, v54
    v_xor_b32 v55, v2, v16
    v_and_b32 v55, 0x70, v55
    v_add_u32 v54, v54, v55
    v_xor_b32 v55, 64, v54
    s_mul_i32 s86, s3, 12288
    s_add_u32 m0, s86, 0
    s_add_u32 s87, s79, 0
    s_waitcnt vmcnt(18)
    buffer_load_dwordx4 v54, s[24:27], s87 offen  lds
    s_add_u32 m0, s86, 1024
    s_add_u32 s87, s79, 12288
    s_waitcnt vmcnt(18)
    buffer_load_dwordx4 v55, s[24:27], s87 offen  lds
    s_add_u32 m0, s86, 2048
    s_add_u32 s87, s79, 128
    s_waitcnt vmcnt(18)
    buffer_load_dwordx4 v54, s[24:27], s87 offen  lds
    s_add_u32 m0, s86, 3072
    s_add_u32 s87, s79, 12416
    s_waitcnt vmcnt(18)
    buffer_load_dwordx4 v55, s[24:27], s87 offen  lds
    s_add_u32 m0, s86, 4096
    s_add_u32 s87, s79, 256
    s_waitcnt vmcnt(18)
    buffer_load_dwordx4 v54, s[24:27], s87 offen  lds
    s_add_u32 m0, s86, 5120
    s_add_u32 s87, s79, 12544
    s_waitcnt vmcnt(18)
    buffer_load_dwordx4 v55, s[24:27], s87 offen  lds
    s_waitcnt vmcnt(6)
m1_O0_go:
    v_mfma_f32_16x16x32_bf16 v[40:43], v[24:27], v[56:59], 0
    v_mfma_f32_16x16x32_bf16 v[44:47], v[24:27], v[60:63], 0
    v_mfma_f32_16x16x32_bf16 v[40:43], v[28:31], v[64:67], v[40:43]
    v_mfma_f32_16x16x32_bf16 v[44:47], v[28:31], v[68:71], v[44:47]
    v_mfma_f32_16x16x32_bf16 v[40:43], v[32:35], v[72:75], v[40:43]
    v_mfma_f32_16x16x32_bf16 v[44:47], v[32:35], v[76:79], v[44:47]
    v_mfma_f32_16x16x32_bf16 v[40:43], v[36:39], v[80:83], v[40:43]
    v_mfma_f32_16x16x32_bf16 v[44:47], v[36:39], v[84:87], v[44:47]
    s_nop 6
    v_pk_add_f32 v[40:41], v[40:41], v[42:43]
    v_pk_add_f32 v[44:45], v[44:45], v[46:47]
    v_add_f32 v40, v40, v41
    v_add_f32 v44, v44, v45
    s_nop 1
    v_permlane16_swap_b32 v40, v44
    v_add_f32 v40, v40, v44
    s_mov_b32 exec_hi, 0
    v_cmp_u_f32 vcc, v40, v40
    s_xor_b32 s86, s67, 8192
    s_cbranch_vccnz m1_O0_rt
m1_O0_ok:
    buffer_store_dword v40, v17, s[56:59], s67 offen sc1
    buffer_store_dword v40, v17, s[56:59], s86 offen sc1
    s_mov_b64 exec, -1
    s_barrier
    v_mov_b32 v48, -1
    v_mov_b32 v49, -1
    v_mov_b32 v50, -1
    v_mov_b32 v51, -1
    s_lshl_b32 s87, s4, 5
    s_add_u32 s87, s87, s5
    s_lshl_b32 s87, s87, 2
    s_add_u32 s87, s87, s3
    s_lshl_b32 s87, s87, 10
    s_add_u32 s98, s87, 4653056
    buffer_store_dwordx4 v[48:51], v2, s[56:59], s98 offen sc1
    s_lshl_b32 s86, s5, 2
    s_add_u32 s86, s86, s3
    s_mul_i32 s86, s86, 288
    s_mul_i32 s87, s4, 36864
    s_add_u32 s86, s86, s87
    s_add_u32 s86, s86, 7798784
    s_mov_b64 exec, 0x3ffff
    buffer_store_dwordx4 v[48:51], v2, s[56:59], s86 offen sc1
    s_mov_b64 exec, -1
    v_and_b32 v52, 8, v1
    v_mul_u32_u24 v52, 1008, v52
    v_add_u32 v52, v52, v2
    s_mov_b64 exec, 0xffff
    s_andn2_b32 s86, s67, 8192
    s_add_u32 s98, s86, 2097152
    buffer_store_dwordx4 v[48:51], v52, s[56:59], s98 offen sc1
    s_add_u32 s98, s86, 4194304
    buffer_store_dwordx4 v[48:51], v52, s[56:59], s98 offen sc1
    s_mov_b64 exec, -1
    s_lshr_b32 s86, s5, 4
    s_mul_i32 s86, s86, 2097152
    s_and_b32 s87, s5, 15
    s_lshl_b32 s87, s87, 2
    s_add_u32 s87, s87, s3
    s_mul_i32 s87, s87, 576
    s_add_u32 s86, s86, s87
    s_mul_i32 s87, s4, 36864
    s_add_u32 s86, s86, s87
    s_add_u32 s86, s86, 3604480
    s_lshl_b32 s87, s3, 11
    s_add_u32 m0, s87, 156672
    v_lshlrev_b32 v89, 6, v1
    s_mov_b64 exec, 0x1ff
    buffer_load_dword v89, s[56:59], s86 offen sc1 lds
    s_mov_b64 exec, -1
    s_lshr_b32 s86, s5, 4
    s_mul_i32 s86, s86, 4194304
    s_and_b32 s87, s5, 15
    s_lshl_b32 s87, s87, 2
    s_add_u32 s87, s87, s3
    s_mul_i32 s87, s87, 576
    s_add_u32 s86, s86, s87
    s_mul_i32 s87, s4, 36864
    s_add_u32 s86, s86, s87
    s_add_u32 s86, s86, 5996544
    s_lshl_b32 s87, s3, 11
    s_add_u32 m0, s87, 156672
    v_lshlrev_b32 v89, 6, v1
    s_mov_b64 exec, 0x1ff
    buffer_load_dword v89, s[56:59], s86 offen sc1 lds
    s_mov_b64 exec, -1
    s_lshr_b32 s86, s5, 3
    s_lshl_b32 s87, s4, 2
    s_add_u32 s86, s86, s87
    s_mul_i32 s98, s86, 384
    s_and_b32 s87, s5, 7
    s_lshl_b32 s87, s87, 2
    s_add_u32 s87, s87, s3
    s_mul_i32 s87, s87, 294912
    s_add_u32 s98, s98, s87
    s_mul_i32 s86, s3, 9216
    v_add_u32 v50, 0, v1
    v_mul_u32_u24 v53, 2731, v50
    v_lshrrev_b32 v53, 16, v53
    v_mul_u32_u24 v53, 11904, v53
    v_lshl_add_u32 v50, v50, 4, v53
    v_add_u32 v51, 64, v1
    v_mul_u32_u24 v53, 2731, v51
    v_lshrrev_b32 v53, 16, v53
    v_mul_u32_u24 v53, 11904, v53
    v_lshl_add_u32 v51, v51, 4, v53
    v_add_u32 v52, 128, v1
    v_mul_u32_u24 v53, 2731, v52
    v_lshrrev_b32 v53, 16, v53
    v_mul_u32_u24 v53, 11904, v53
    v_lshl_add_u32 v52, v52, 4, v53
    s_add_u32 m0, s86, 49152
    s_nop 0
    buffer_load_dwordx4 v50, s[36:39], s98 offen nt lds
    s_add_u32 m0, s86, 50176
    s_nop 0
    buffer_load_dwordx4 v51, s[36:39], s98 offen nt lds
    s_add_u32 m0, s86, 51200
    s_nop 0
    buffer_load_dwordx4 v52, s[36:39], s98 offen nt lds
    s_add_u32 s98, s98, 98304
    s_add_u32 m0, s86, 52224
    s_nop 0
    buffer_load_dwordx4 v50, s[36:39], s98 offen nt lds
    s_add_u32 m0, s86, 53248
    s_nop 0
    buffer_load_dwordx4 v51, s[36:39], s98 offen nt lds
    s_add_u32 m0, s86, 54272
    s_nop 0
    buffer_load_dwordx4 v52, s[36:39], s98 offen nt lds
    s_add_u32 s98, s98, 98304
    s_add_u32 m0, s86, 55296
    s_nop 0
    buffer_load_dwordx4 v50, s[36:39], s98 offen nt lds
    s_add_u32 m0, s86, 56320
    s_nop 0
    buffer_load_dwordx4 v51, s[36:39], s98 offen nt lds
    s_add_u32 m0, s86, 57344
    s_waitcnt vmcnt(15)
    buffer_load_dwordx4 v52, s[36:39], s98 offen nt lds
    v_add_u32 v52, 0, v1
    v_mul_u32_u24 v55, 10923, v52
    v_lshrrev_b32 v55, 16, v55
    v_mul_u32_u24 v55, 1440, v55
    v_lshl_add_u32 v52, v52, 4, v55
    v_add_u32 v53, 64, v1
    v_mul_u32_u24 v55, 10923, v53
    v_lshrrev_b32 v55, 16, v55
    v_mul_u32_u24 v55, 1440, v55
    v_lshl_add_u32 v53, v53, 4, v55
    v_add_u32 v54, 128, v1
    v_mul_u32_u24 v55, 10923, v54
    v_lshrrev_b32 v55, 16, v55
    v_mul_u32_u24 v55, 1440, v55
    v_lshl_add_u32 v54, v54, 4, v55
    s_mul_i32 s86, s3, 12288
    s_add_u32 s87, s77, 49152
    s_add_u32 m0, s86, 6144
    s_waitcnt vmcnt(15)
    buffer_load_dwordx4 v52, s[24:27], s77 offen lds
    s_add_u32 m0, s86, 7168
    s_waitcnt vmcnt(15)
    buffer_load_dwordx4 v53, s[24:27], s77 offen lds
    s_add_u32 m0, s86, 8192
    s_waitcnt vmcnt(15)
    buffer_load_dwordx4 v54, s[24:27], s77 offen lds
    s_add_u32 m0, s86, 9216
    s_waitcnt vmcnt(15)
    buffer_load_dwordx4 v52, s[24:27], s87 offen lds
    s_add_u32 m0, s86, 10240
    s_waitcnt vmcnt(15)
    buffer_load_dwordx4 v53, s[24:27], s87 offen lds
    s_add_u32 m0, s86, 11264
    s_waitcnt vmcnt(13)
    buffer_load_dwordx4 v54, s[24:27], s87 offen lds
    s_mov_b32 s83, s80
    s_mov_b32 s84, s79
    s_and_b32 s86, s3, 1
    s_lshl_b32 s79, s86, 19
    s_lshl_b32 s86, s4, 15
    s_add_u32 s79, s79, s86
    s_lshr_b32 s86, s5, 4
    s_lshl_b32 s86, s86, 14
    s_add_u32 s79, s79, s86
    s_lshr_b32 s86, s3, 1
    s_lshl_b32 s86, s86, 13
    s_add_u32 s79, s79, s86
    s_and_b32 s86, s5, 15
    s_lshl_b32 s86, s86, 9
    s_add_u32 s79, s79, s86
    s_add_u32 s79, s79, 2555904
    s_and_b32 s86, s4, 3
    s_lshl_b32 s80, s86, 18
    s_lshr_b32 s86, s4, 2
    s_lshl_b32 s86, s86, 13
    s_add_u32 s80, s80, s86
    s_and_b32 s86, s5, 4
    s_lshl_b32 s86, s86, 12
    s_add_u32 s80, s80, s86
    s_and_b32 s86, s5, 3
    s_lshl_b32 s86, s86, 11
    s_add_u32 s80, s80, s86
    s_lshl_b32 s86, s3, 9
    s_add_u32 s80, s80, s86
    s_lshr_b32 s86, s5, 3
    s_lshl_b32 s86, s86, 7
    s_add_u32 s80, s80, s86
    s_add_u32 s80, s80, 2555904
    s_lshr_b32 s86, s4, 2
    s_xor_b32 s86, s86, 1
    s_lshl_b32 s86, s86, 13
    s_xor_b32 s67, s67, s86
    s_xor_b32 s73, s73, s86
    s_branch m1_E
m1_bar_slow:
    s_sub_u32 s60, s60, 1
    s_cbranch_scc1 m1_bar_to
    s_sleep 8
    s_mov_b32 s86, 524288
    buffer_load_dword v88, v36, s[56:59], s86 offen sc1
    s_add_u32 s86, s86, 2048
    buffer_load_dword v89, v36, s[56:59], s86 offen sc1
    s_add_u32 s86, s86, 2048
    buffer_load_dword v90, v36, s[56:59], s86 offen sc1
    s_add_u32 s86, s86, 2048
    buffer_load_dword v91, v36, s[56:59], s86 offen sc1
    s_waitcnt vmcnt(0)
    s_branch m1_bar_chk
m1_bar_to:
    s_mov_b32 s60, 0
    s_branch m1_bar_ok
m1_go_slow:
    s_sub_u32 s60, s60, 1
    s_cbranch_scc1 m1_go_to
    s_sleep 8
    buffer_load_dwordx4 v[24:27], v2, s[52:55], 0 offen offset:192 sc1
    s_waitcnt vmcnt(0)
    s_branch m1_go_chk
m1_go_to:
    s_mov_b32 s60, 0
    s_branch m1_go_ok
m1_layer:
    s_and_b32 s86, s7, 1
    s_cselect_b32 s62, s1, s85
    s_lshl_b32 s86, s86, 15
    v_add_u32 v48, s86, v9
    v_xor_b32 v49, 32, v48
    ds_read_b64_tr_b16 v[56:57], v48 offset:0
    ds_read_b64_tr_b16 v[58:59], v48 offset:1024
    ds_read_b64_tr_b16 v[60:61], v49 offset:0
    ds_read_b64_tr_b16 v[62:63], v49 offset:1024
    ds_read_b64_tr_b16 v[64:65], v48 offset:8192
    ds_read_b64_tr_b16 v[66:67], v48 offset:9216
    ds_read_b64_tr_b16 v[68:69], v49 offset:8192
    ds_read_b64_tr_b16 v[70:71], v49 offset:9216
    ds_read_b64_tr_b16 v[72:73], v48 offset:16384
    ds_read_b64_tr_b16 v[74:75], v48 offset:17408
    ds_read_b64_tr_b16 v[76:77], v49 offset:16384
    ds_read_b64_tr_b16 v[78:79], v49 offset:17408
    ds_read_b64_tr_b16 v[80:81], v48 offset:24576
    ds_read_b64_tr_b16 v[82:83], v48 offset:25600
    ds_read_b64_tr_b16 v[84:85], v49 offset:24576
    ds_read_b64_tr_b16 v[86:87], v49 offset:25600
    v_mov_b32 v52, 0x3f803f80
    v_cmp_eq_u32 vcc, 1, v23
    s_nop 1
    v_cndmask_b32 v24, 0, v52, vcc
    v_mov_b32 v25, v24
    v_mov_b32 v26, v24
    v_mov_b32 v27, v24
    v_mov_b32 v28, v24
    v_mov_b32 v29, v24
    v_mov_b32 v30, v24
    v_mov_b32 v31, v24
    v_mov_b32 v32, v24
    v_mov_b32 v33, v24
    v_mov_b32 v34, v24
    v_mov_b32 v35, v24
    v_mov_b32 v36, v24
    v_mov_b32 v37, v24
    v_mov_b32 v38, v24
    v_mov_b32 v39, v24
    v_mov_b32 v40, 0
    v_mov_b32 v41, 0
    v_mov_b32 v42, 0
    v_mov_b32 v43, 0
    s_mov_b64 exec, 0x3ff
    buffer_load_dwordx4 v[40:43], v2, s[56:59], s72 offen sc1
    s_mov_b64 exec, s[88:89]
    buffer_load_dwordx4 v[24:27], v16, s[56:59], s70 offen offset:0 sc1
    buffer_load_dwordx4 v[28:31], v16, s[56:59], s70 offen offset:64 sc1
    buffer_load_dwordx4 v[32:35], v16, s[56:59], s70 offen offset:128 sc1
    buffer_load_dwordx4 v[36:39], v16, s[56:59], s70 offen offset:192 sc1
    s_mov_b64 exec, -1
    s_waitcnt lgkmcnt(0)
m1_P_go:
    s_mov_b32 s86, 0x3727c5ac
    s_waitcnt vmcnt(4)
    v_add_f32 v52, v40, v42
    v_add_f32 v53, v41, v43
    v_cmp_u_f32 vcc, v52, v53
    s_cbranch_vccnz m1_P_rq
m1_P_rqo:
    s_waitcnt vmcnt(3)
    v_mfma_f32_16x16x32_bf16 v[44:47], v[24:27], v[56:59], 0
    v_mfma_f32_16x16x32_bf16 v[48:51], v[24:27], v[60:63], 0
    v_add_f32_dpp v52, v52, v52 row_ror:8 row_mask:0xf bank_mask:0xf
    v_add_f32_dpp v53, v53, v53 row_ror:8 row_mask:0xf bank_mask:0xf
    s_waitcnt vmcnt(2)
    v_mfma_f32_16x16x32_bf16 v[44:47], v[28:31], v[64:67], v[44:47]
    v_add_f32_dpp v52, v52, v52 row_ror:4 row_mask:0xf bank_mask:0xf
    v_add_f32_dpp v53, v53, v53 row_ror:4 row_mask:0xf bank_mask:0xf
    v_mfma_f32_16x16x32_bf16 v[48:51], v[28:31], v[68:71], v[48:51]
    v_add_f32_dpp v52, v52, v52 row_ror:2 row_mask:0xf bank_mask:0xf
    v_add_f32_dpp v53, v53, v53 row_ror:2 row_mask:0xf bank_mask:0xf
    s_waitcnt vmcnt(1)
    v_mfma_f32_16x16x32_bf16 v[44:47], v[32:35], v[72:75], v[44:47]
    v_add_f32_dpp v52, v52, v52 row_ror:1 row_mask:0xf bank_mask:0xf
    v_add_f32_dpp v53, v53, v53 row_ror:1 row_mask:0xf bank_mask:0xf
    v_mfma_f32_16x16x32_bf16 v[48:51], v[32:35], v[76:79], v[48:51]
    v_mul_f32 v52, 0x3acccccd, v52
    v_mul_f32 v53, 0x3acccccd, v53
    s_waitcnt vmcnt(0)
    v_mfma_f32_16x16x32_bf16 v[44:47], v[36:39], v[80:83], v[44:47]
    v_fma_f32 v53, -v52, v52, v53
    v_add_f32 v53, s86, abs(v53)
    v_mfma_f32_16x16x32_bf16 v[48:51], v[36:39], v[84:87], v[48:51]
    v_rsq_f32 v53, v53
    s_nop 0
    v_mul_f32 v52, v52, v53
    s_nop 1
    v_mul_f32 v54, v44, v53
    s_nop 1
    v_mul_f32 v55, v48, v53
    v_fma_f32 v54, -v52, v45, v54
    v_fma_f32 v55, -v52, v49, v55
    s_mov_b64 exec, 0xffff
    v_cmp_u_f32 vcc, v54, v55
    s_cbranch_vccnz m1_P_rt
m1_P_ok:
    buffer_store_dword v54, v17, s[56:59], s61 offen sc1
    buffer_store_dword v55, v17, s[56:59], s61 offen offset:64 sc1
    s_mov_b64 exec, -1
    s_barrier
    s_sleep 2
m1_Q_try:
    s_mov_b32 exec_lo, -1
    s_mov_b32 exec_hi, 0xffff
    buffer_load_dwordx4 v[24:27], v2, s[56:59], s62 offen offset:0 sc1
    buffer_load_dwordx4 v[28:31], v2, s[56:59], s62 offen offset:768 sc1
    buffer_load_dwordx4 v[32:35], v2, s[56:59], s62 offen offset:1536 sc1
    buffer_load_dwordx4 v[36:39], v2, s[56:59], s62 offen offset:2304 sc1
    buffer_load_dwordx4 v[40:43], v2, s[56:59], s62 offen offset:3072 sc1
    s_waitcnt vmcnt(3)
    v_pk_add_f32 v[44:45], v[24:25], v[28:29]
    v_pk_add_f32 v[46:47], v[26:27], v[30:31]
    s_waitcnt vmcnt(2)
    v_pk_add_f32 v[44:45], v[44:45], v[32:33]
    v_pk_add_f32 v[46:47], v[46:47], v[34:35]
    s_waitcnt vmcnt(1)
    v_pk_add_f32 v[44:45], v[44:45], v[36:37]
    v_pk_add_f32 v[46:47], v[46:47], v[38:39]
    s_waitcnt vmcnt(0)
    v_pk_add_f32 v[44:45], v[44:45], v[40:41]
    v_pk_add_f32 v[46:47], v[46:47], v[42:43]
    v_cvt_pk_bf16_f32 v48, v44, v45
    v_cvt_pk_bf16_f32 v49, v46, v47
    ds_write_b64 v14, v[48:49]
    v_add_f32 v50, v44, v45
    v_add_f32 v51, v46, v47
    v_cmp_u_f32 vcc, v50, v51
    s_cbranch_vccnz m1_Q_rt
m1_Q_ok:
    s_mov_b64 exec, -1
    ds_read_b128 v[32:35], v5 offset:0
    ds_read_b128 v[36:39], v5 offset:128
    ds_read_b128 v[40:43], v5 offset:256
    ds_read_b128 v[44:47], v6 offset:0
    ds_read_b128 v[48:51], v6 offset:128
    ds_read_b128 v[52:55], v6 offset:256
    s_bitcmp1_b32 s7, 0
    s_cbranch_scc1 m1_layerB
    buffer_store_dwordx4 v[88:91], v2, s[56:59], s14 offen sc1
    s_mov_b32 exec_hi, 0xf
    buffer_store_dwordx4 v[88:91], v2, s[56:59], s18 offen sc1
    s_mov_b64 exec, 0xff
    buffer_store_dwordx4 v[88:91], v2, s[56:59], s30 offen sc1
    buffer_store_dwordx4 v[88:91], v2, s[56:59], s38 offen sc1
    s_mov_b64 exec, 0x3f
    buffer_store_dwordx4 v[88:91], v2, s[56:59], s34 offen sc1
    s_mov_b64 exec, -1
m1_QK:
    s_waitcnt lgkmcnt(5)
    v_mfma_f32_16x16x32_bf16 v[56:59], a[0:3], v[32:35], 0
    s_waitcnt lgkmcnt(4)
    v_mfma_f32_16x16x32_bf16 v[56:59], a[4:7], v[36:39], v[56:59]
    s_waitcnt lgkmcnt(3)
    v_mfma_f32_16x16x32_bf16 v[56:59], a[8:11], v[40:43], v[56:59]
    s_waitcnt lgkmcnt(2)
    v_mfma_f32_16x16x32_bf16 v[56:59], a[12:15], v[44:47], v[56:59]
    s_waitcnt lgkmcnt(1)
    v_mfma_f32_16x16x32_bf16 v[56:59], a[16:19], v[48:51], v[56:59]
    s_waitcnt lgkmcnt(0)
    v_mfma_f32_16x16x32_bf16 v[56:59], a[20:23], v[52:55], v[56:59]
    v_mfma_f32_16x16x32_bf16 v[60:63], a[24:27], v[32:35], 0
    v_mfma_f32_16x16x32_bf16 v[60:63], a[28:31], v[36:39], v[60:63]
    v_mfma_f32_16x16x32_bf16 v[60:63], a[32:35], v[40:43], v[60:63]
    v_mfma_f32_16x16x32_bf16 v[60:63], a[36:39], v[44:47], v[60:63]
    v_mfma_f32_16x16x32_bf16 v[60:63], a[40:43], v[48:51], v[60:63]
    v_mfma_f32_16x16x32_bf16 v[60:63], a[44:47], v[52:55], v[60:63]
    s_nop 1
    v_mov_b32_dpp v72, v56 quad_perm:[0,0,0,0] row_mask:0xf bank_mask:0xf
    v_add_f32_dpp v72, v57, v72 quad_perm:[1,1,1,1] row_mask:0xf bank_mask:0xf
    v_add_f32_dpp v72, v58, v72 quad_perm:[2,2,2,2] row_mask:0xf bank_mask:0xf
    v_add_f32_dpp v72, v59, v72 quad_perm:[3,3,3,3] row_mask:0xf bank_mask:0xf
    v_mfma_f32_16x16x32_bf16 v[64:67], a[48:51], v[32:35], 0
    v_mfma_f32_16x16x32_bf16 v[64:67], a[52:55], v[36:39], v[64:67]
    v_mfma_f32_16x16x32_bf16 v[64:67], a[56:59], v[40:43], v[64:67]
    v_mfma_f32_16x16x32_bf16 v[64:67], a[60:63], v[44:47], v[64:67]
    v_mfma_f32_16x16x32_bf16 v[64:67], a[64:67], v[48:51], v[64:67]
    v_mfma_f32_16x16x32_bf16 v[64:67], a[68:71], v[52:55], v[64:67]
    v_mov_b32_dpp v73, v60 quad_perm:[0,0,0,0] row_mask:0xf bank_mask:0xf
    v_add_f32_dpp v73, v61, v73 quad_perm:[1,1,1,1] row_mask:0xf bank_mask:0xf
    v_add_f32_dpp v73, v62, v73 quad_perm:[2,2,2,2] row_mask:0xf bank_mask:0xf
    v_add_f32_dpp v73, v63, v73 quad_perm:[3,3,3,3] row_mask:0xf bank_mask:0xf
    v_mfma_f32_16x16x32_bf16 v[68:71], a[72:75], v[32:35], 0
    v_mfma_f32_16x16x32_bf16 v[68:71], a[76:79], v[36:39], v[68:71]
    v_mfma_f32_16x16x32_bf16 v[68:71], a[80:83], v[40:43], v[68:71]
    v_mfma_f32_16x16x32_bf16 v[68:71], a[84:87], v[44:47], v[68:71]
    v_mfma_f32_16x16x32_bf16 v[68:71], a[88:91], v[48:51], v[68:71]
    v_mfma_f32_16x16x32_bf16 v[68:71], a[92:95], v[52:55], v[68:71]
    v_mov_b32_dpp v74, v64 quad_perm:[0,0,0,0] row_mask:0xf bank_mask:0xf
    v_add_f32_dpp v74, v65, v74 quad_perm:[1,1,1,1] row_mask:0xf bank_mask:0xf
    v_add_f32_dpp v74, v66, v74 quad_perm:[2,2,2,2] row_mask:0xf bank_mask:0xf
    v_add_f32_dpp v74, v67, v74 quad_perm:[3,3,3,3] row_mask:0xf bank_mask:0xf
    v_mfma_f32_16x16x32_bf16 v[56:59], a[96:99], v[32:35], 0
    v_mfma_f32_16x16x32_bf16 v[56:59], a[100:103], v[36:39], v[56:59]
    v_mfma_f32_16x16x32_bf16 v[56:59], a[104:107], v[40:43], v[56:59]
    v_mfma_f32_16x16x32_bf16 v[56:59], a[108:111], v[44:47], v[56:59]
    v_mfma_f32_16x16x32_bf16 v[56:59], a[112:115], v[48:51], v[56:59]
    v_mfma_f32_16x16x32_bf16 v[56:59], a[116:119], v[52:55], v[56:59]
    v_mov_b32_dpp v75, v68 quad_perm:[0,0,0,0] row_mask:0xf bank_mask:0xf
    v_add_f32_dpp v75, v69, v75 quad_perm:[1,1,1,1] row_mask:0xf bank_mask:0xf
    v_add_f32_dpp v75, v70, v75 quad_perm:[2,2,2,2] row_mask:0xf bank_mask:0xf
    v_add_f32_dpp v75, v71, v75 quad_perm:[3,3,3,3] row_mask:0xf bank_mask:0xf
    v_mfma_f32_16x16x32_bf16 v[60:63], a[120:123], v[32:35], 0
    v_mfma_f32_16x16x32_bf16 v[60:63], a[124:127], v[36:39], v[60:63]
    v_mfma_f32_16x16x32_bf16 v[60:63], a[128:131], v[40:43], v[60:63]
    v_mfma_f32_16x16x32_bf16 v[60:63], a[132:135], v[44:47], v[60:63]
    v_mfma_f32_16x16x32_bf16 v[60:63], a[136:139], v[48:51], v[60:63]
    v_mfma_f32_16x16x32_bf16 v[60:63], a[140:143], v[52:55], v[60:63]
    v_mov_b32_dpp v76, v56 quad_perm:[0,0,0,0] row_mask:0xf bank_mask:0xf
    v_add_f32_dpp v76, v57, v76 quad_perm:[1,1,1,1] row_mask:0xf bank_mask:0xf
    v_add_f32_dpp v76, v58, v76 quad_perm:[2,2,2,2] row_mask:0xf bank_mask:0xf
    v_add_f32_dpp v76, v59, v76 quad_perm:[3,3,3,3] row_mask:0xf bank_mask:0xf
    v_mfma_f32_16x16x32_bf16 v[64:67], a[144:147], v[32:35], 0
    v_mfma_f32_16x16x32_bf16 v[64:67], a[148:151], v[36:39], v[64:67]
    v_mfma_f32_16x16x32_bf16 v[64:67], a[152:155], v[40:43], v[64:67]
    v_mfma_f32_16x16x32_bf16 v[64:67], a[156:159], v[44:47], v[64:67]
    v_mfma_f32_16x16x32_bf16 v[64:67], a[160:163], v[48:51], v[64:67]
    v_mfma_f32_16x16x32_bf16 v[64:67], a[164:167], v[52:55], v[64:67]
    v_mov_b32_dpp v77, v60 quad_perm:[0,0,0,0] row_mask:0xf bank_mask:0xf
    v_add_f32_dpp v77, v61, v77 quad_perm:[1,1,1,1] row_mask:0xf bank_mask:0xf
    v_add_f32_dpp v77, v62, v77 quad_perm:[2,2,2,2] row_mask:0xf bank_mask:0xf
    v_add_f32_dpp v77, v63, v77 quad_perm:[3,3,3,3] row_mask:0xf bank_mask:0xf
    v_mfma_f32_16x16x32_bf16 v[68:71], a[168:171], v[32:35], 0
    v_mfma_f32_16x16x32_bf16 v[68:71], a[172:175], v[36:39], v[68:71]
    v_mfma_f32_16x16x32_bf16 v[68:71], a[176:179], v[40:43], v[68:71]
    v_mfma_f32_16x16x32_bf16 v[68:71], a[180:183], v[44:47], v[68:71]
    v_mfma_f32_16x16x32_bf16 v[68:71], a[184:187], v[48:51], v[68:71]
    v_mfma_f32_16x16x32_bf16 v[68:71], a[188:191], v[52:55], v[68:71]
    v_mov_b32_dpp v78, v64 quad_perm:[0,0,0,0] row_mask:0xf bank_mask:0xf
    v_add_f32_dpp v78, v65, v78 quad_perm:[1,1,1,1] row_mask:0xf bank_mask:0xf
    v_add_f32_dpp v78, v66, v78 quad_perm:[2,2,2,2] row_mask:0xf bank_mask:0xf
    v_add_f32_dpp v78, v67, v78 quad_perm:[3,3,3,3] row_mask:0xf bank_mask:0xf
    s_nop 3
    v_mov_b32_dpp v79, v68 quad_perm:[0,0,0,0] row_mask:0xf bank_mask:0xf
    v_add_f32_dpp v79, v69, v79 quad_perm:[1,1,1,1] row_mask:0xf bank_mask:0xf
    v_add_f32_dpp v79, v70, v79 quad_perm:[2,2,2,2] row_mask:0xf bank_mask:0xf
    v_add_f32_dpp v79, v71, v79 quad_perm:[3,3,3,3] row_mask:0xf bank_mask:0xf
    v_max3_f32 v80, v72, v73, v74
    v_max3_f32 v80, v80, v75, v76
    v_max3_f32 v80, v80, v77, v78
    v_max_f32 v80, v80, v79
    s_nop 1
    v_max_f32_dpp v80, v80, v80 row_ror:4 row_mask:0xf bank_mask:0xf
    s_nop 1
    v_max_f32_dpp v80, v80, v80 row_ror:8 row_mask:0xf bank_mask:0xf
    v_mov_b32 v82, v80
    s_nop 1
    v_permlane16_swap_b32 v80, v82
    v_max_f32 v80, v80, v82
    v_mov_b32 v82, v80
    s_nop 1
    v_permlane32_swap_b32 v80, v82
    v_max_f32 v80, v80, v82
    s_mov_b32 s86, 0x3dd53b95
    v_mul_f32 v84, s86, v80
    v_fma_f32 v72, v72, s86, -v84
    v_fma_f32 v73, v73, s86, -v84
    v_fma_f32 v74, v74, s86, -v84
    v_fma_f32 v75, v75, s86, -v84
    v_fma_f32 v76, v76, s86, -v84
    v_fma_f32 v77, v77, s86, -v84
    v_fma_f32 v78, v78, s86, -v84
    v_fma_f32 v79, v79, s86, -v84
    v_exp_f32 v72, v72
    v_exp_f32 v73, v73
    v_exp_f32 v74, v74
    v_exp_f32 v75, v75
    v_exp_f32 v76, v76
    v_exp_f32 v77, v77
    v_exp_f32 v78, v78
    v_exp_f32 v79, v79
    v_cvt_pk_bf16_f32 v56, v72, v73
    v_cvt_pk_bf16_f32 v57, v74, v75
    v_cvt_pk_bf16_f32 v58, v76, v77
    v_cvt_pk_bf16_f32 v59, v78, v79
    ds_write_b128 v8, v[56:59]
    v_add_f32 v85, v72, v73
    v_add_f32 v85, v85, v74
    v_add_f32 v85, v85, v75
    v_add_f32 v85, v85, v76
    v_add_f32 v85, v85, v77
    v_add_f32 v85, v85, v78
    v_add_f32 v85, v85, v79
    s_nop 1
    v_add_f32_dpp v85, v85, v85 row_ror:4 row_mask:0xf bank_mask:0xf
    s_nop 1
    v_add_f32_dpp v85, v85, v85 row_ror:8 row_mask:0xf bank_mask:0xf
    v_mov_b32 v82, v85
    s_nop 1
    v_permlane16_swap_b32 v85, v82
    v_add_f32 v85, v85, v82
    v_mov_b32 v82, v85
    s_nop 1
    v_permlane32_swap_b32 v85, v82
    v_add_f32 v85, v85, v82
    s_mov_b64 exec, 1
    buffer_store_dwordx2 v[84:85], v17, s[56:59], s63 offen sc1
    s_mov_b64 exec, -1
    s_cmp_eq_u32 s7, 0
    s_cbranch_scc1 m1_stream2
m1_PV:
    s_waitcnt lgkmcnt(0)
    s_barrier
    ds_read_b128 v[56:59], v7 offset:0
    ds_read_b128 v[60:63], v7 offset:64
    ds_read_b128 v[64:67], v7 offset:128
    ds_read_b128 v[68:71], v7 offset:192
    ds_read_b128 v[72:75], v7 offset:256
    ds_read_b128 v[76:79], v7 offset:320
    ds_read_b128 v[80:83], v7 offset:384
    ds_read_b128 v[84:87], v7 offset:448
    s_cmp_eq_u32 s7, 0
    s_waitcnt lgkmcnt(7)
    v_mfma_f32_16x16x32_bf16 v[24:27], v[56:59], v[92:95], 0
    v_mfma_f32_16x16x32_bf16 v[28:31], v[56:59], v[96:99], 0
    v_mfma_f32_16x16x32_bf16 v[32:35], v[56:59], v[100:103], 0
    ds_read_b128 v[56:59], v7 offset:512
    s_waitcnt lgkmcnt(7)
    v_mfma_f32_16x16x32_bf16 v[24:27], v[60:63], v[104:107], v[24:27]
    v_mfma_f32_16x16x32_bf16 v[28:31], v[60:63], v[108:111], v[28:31]
    v_mfma_f32_16x16x32_bf16 v[32:35], v[60:63], v[112:115], v[32:35]
    ds_read_b128 v[60:63], v7 offset:576
    s_waitcnt lgkmcnt(7)
    s_cbranch_scc1 m1_pv_a
    buffer_load_dwordx4 v[36:39], v13, s[56:59], s64 offen sc1
m1_pv_a:
    v_mfma_f32_16x16x32_bf16 v[24:27], v[64:67], v[116:119], v[24:27]
    v_mfma_f32_16x16x32_bf16 v[28:31], v[64:67], v[120:123], v[28:31]
    v_mfma_f32_16x16x32_bf16 v[32:35], v[64:67], v[124:127], v[32:35]
    ds_read_b128 v[64:67], v7 offset:640
    s_waitcnt lgkmcnt(7)
    v_mfma_f32_16x16x32_bf16 v[24:27], v[68:71], v[128:131], v[24:27]
    v_mfma_f32_16x16x32_bf16 v[28:31], v[68:71], v[132:135], v[28:31]
    v_mfma_f32_16x16x32_bf16 v[32:35], v[68:71], v[136:139], v[32:35]
    ds_read_b128 v[68:71], v7 offset:704
    s_waitcnt lgkmcnt(7)
    v_mfma_f32_16x16x32_bf16 v[24:27], v[72:75], v[140:143], v[24:27]
    v_mfma_f32_16x16x32_bf16 v[28:31], v[72:75], v[144:147], v[28:31]
    v_mfma_f32_16x16x32_bf16 v[32:35], v[72:75], v[148:151], v[32:35]
    ds_read_b128 v[72:75], v7 offset:768
    s_waitcnt lgkmcnt(7)
    v_mfma_f32_16x16x32_bf16 v[24:27], v[76:79], v[152:155], v[24:27]
    v_mfma_f32_16x16x32_bf16 v[28:31], v[76:79], v[156:159], v[28:31]
    v_mfma_f32_16x16x32_bf16 v[32:35], v[76:79], v[160:163], v[32:35]
    ds_read_b128 v[76:79], v7 offset:832
    s_waitcnt lgkmcnt(7)
    v_mfma_f32_16x16x32_bf16 v[24:27], v[80:83], v[164:167], v[24:27]
    v_mfma_f32_16x16x32_bf16 v[28:31], v[80:83], v[168:171], v[28:31]
    v_mfma_f32_16x16x32_bf16 v[32:35], v[80:83], v[172:175], v[32:35]
    ds_read_b128 v[80:83], v7 offset:896
    s_waitcnt lgkmcnt(7)
    v_mfma_f32_16x16x32_bf16 v[24:27], v[84:87], v[176:179], v[24:27]
    v_mfma_f32_16x16x32_bf16 v[28:31], v[84:87], v[180:183], v[28:31]
    v_mfma_f32_16x16x32_bf16 v[32:35], v[84:87], v[184:187], v[32:35]
    ds_read_b128 v[84:87], v7 offset:960
    s_waitcnt lgkmcnt(7)
    s_cbranch_scc1 m1_pv_b
    s_waitcnt vmcnt(0)
m1_pv_b:
    v_mfma_f32_16x16x32_bf16 v[24:27], v[56:59], v[188:191], v[24:27]
    v_max_f32 v40, v36, v38
    v_mfma_f32_16x16x32_bf16 v[28:31], v[56:59], v[192:195], v[28:31]
    v_mfma_f32_16x16x32_bf16 v[32:35], v[56:59], v[196:199], v[32:35]
    v_max_f32_dpp v40, v40, v40 row_ror:8 row_mask:0xf bank_mask:0xf
    s_waitcnt lgkmcnt(6)
    v_mfma_f32_16x16x32_bf16 v[24:27], v[60:63], v[200:203], v[24:27]
    v_max_f32_dpp v40, v40, v40 row_ror:4 row_mask:0xf bank_mask:0xf
    v_mfma_f32_16x16x32_bf16 v[28:31], v[60:63], v[204:207], v[28:31]
    v_mfma_f32_16x16x32_bf16 v[32:35], v[60:63], v[208:211], v[32:35]
    v_max_f32_dpp v40, v40, v40 row_ror:2 row_mask:0xf bank_mask:0xf
    s_waitcnt lgkmcnt(5)
    v_mfma_f32_16x16x32_bf16 v[24:27], v[64:67], v[212:215], v[24:27]
    v_max_f32_dpp v40, v40, v40 row_ror:1 row_mask:0xf bank_mask:0xf
    v_mfma_f32_16x16x32_bf16 v[28:31], v[64:67], v[216:219], v[28:31]
    v_sub_f32 v41, v36, v40
    v_mfma_f32_16x16x32_bf16 v[32:35], v[64:67], v[220:223], v[32:35]
    v_sub_f32 v42, v38, v40
    s_waitcnt lgkmcnt(4)
    v_mfma_f32_16x16x32_bf16 v[24:27], v[68:71], v[224:227], v[24:27]
    v_exp_f32 v41, v41
    v_mfma_f32_16x16x32_bf16 v[28:31], v[68:71], v[228:231], v[28:31]
    v_exp_f32 v42, v42
    v_mfma_f32_16x16x32_bf16 v[32:35], v[68:71], v[232:235], v[32:35]
    v_mul_f32 v43, v41, v37
    s_waitcnt lgkmcnt(3)
    v_mfma_f32_16x16x32_bf16 v[24:27], v[72:75], v[236:239], v[24:27]
    v_fmac_f32 v43, v42, v39
    v_mfma_f32_16x16x32_bf16 v[28:31], v[72:75], v[240:243], v[28:31]
    v_mfma_f32_16x16x32_bf16 v[32:35], v[72:75], v[244:247], v[32:35]
    v_add_f32_dpp v43, v43, v43 row_ror:8 row_mask:0xf bank_mask:0xf
    s_waitcnt lgkmcnt(2)
    v_mfma_f32_16x16x32_bf16 v[24:27], v[76:79], v[248:251], v[24:27]
    v_add_f32_dpp v43, v43, v43 row_ror:4 row_mask:0xf bank_mask:0xf
    v_mfma_f32_16x16x32_bf16 v[28:31], v[76:79], v[252:255], v[28:31]
    v_mfma_f32_16x16x32_bf16 v[32:35], v[76:79], a[228:231], v[32:35]
    v_add_f32_dpp v43, v43, v43 row_ror:2 row_mask:0xf bank_mask:0xf
    s_waitcnt lgkmcnt(1)
    v_mfma_f32_16x16x32_bf16 v[24:27], v[80:83], a[232:235], v[24:27]
    v_add_f32_dpp v43, v43, v43 row_ror:1 row_mask:0xf bank_mask:0xf
    v_mfma_f32_16x16x32_bf16 v[28:31], v[80:83], a[236:239], v[28:31]
    v_cmp_u_f32 vcc, v43, v43
    v_mfma_f32_16x16x32_bf16 v[32:35], v[80:83], a[240:243], v[32:35]
    v_rcp_f32 v43, v43
    s_waitcnt lgkmcnt(0)
    v_mfma_f32_16x16x32_bf16 v[24:27], v[84:87], a[244:247], v[24:27]
    v_mul_f32 v41, v41, v43
    v_mfma_f32_16x16x32_bf16 v[28:31], v[84:87], a[248:251], v[28:31]
    v_mul_f32 v42, v42, v43
    v_mfma_f32_16x16x32_bf16 v[32:35], v[84:87], a[252:255], v[32:35]
    s_cbranch_vccnz m1_ML_rt
m1_ML_ok:
    s_nop 2
    v_mul_f32_dpp v44, v41, v24 row_newbcast:0 row_mask:0x1 bank_mask:0xf
    s_nop 0
    v_mul_f32_dpp v44, v41, v28 row_newbcast:0 row_mask:0x2 bank_mask:0xf
    s_nop 0
    v_mul_f32_dpp v44, v41, v32 row_newbcast:0 row_mask:0x4 bank_mask:0xf
    v_fmac_f32_dpp v44, v42, v25 row_newbcast:0 row_mask:0x1 bank_mask:0xf
    v_fmac_f32_dpp v44, v42, v29 row_newbcast:0 row_mask:0x2 bank_mask:0xf
    v_fmac_f32_dpp v44, v42, v33 row_newbcast:0 row_mask:0x4 bank_mask:0xf
    v_fmac_f32_dpp v44, v41, v26 row_newbcast:1 row_mask:0x1 bank_mask:0xf
    v_fmac_f32_dpp v44, v41, v30 row_newbcast:1 row_mask:0x2 bank_mask:0xf
    v_fmac_f32_dpp v44, v41, v34 row_newbcast:1 row_mask:0x4 bank_mask:0xf
    v_fmac_f32_dpp v44, v42, v27 row_newbcast:1 row_mask:0x1 bank_mask:0xf
    v_fmac_f32_dpp v44, v42, v31 row_newbcast:1 row_mask:0x2 bank_mask:0xf
    v_fmac_f32_dpp v44, v42, v35 row_newbcast:1 row_mask:0x4 bank_mask:0xf
    s_nop 1
    v_mov_b32_dpp v45, v44 row_shl:1 row_mask:0xf bank_mask:0xf
    v_cvt_pk_bf16_f32 v44, v44, v45
    s_mov_b64 exec, s[90:91]
    buffer_store_dword v44, v18, s[56:59], s65 offen sc1
    s_mov_b64 exec, -1
m1_O:
    s_cmp_eq_u32 s7, 0
    s_cbranch_scc1 m1_stream3
    s_barrier
    s_mul_i32 s86, s3, 10240
    s_sub_u32 s86, 155648, s86
    v_add_u32 v50, s86, v21
    ds_read_b64_tr_b16 v[56:57], v21 offset:0
    ds_read_b64_tr_b16 v[58:59], v21 offset:256
    ds_read_b64_tr_b16 v[60:61], v21 offset:32
    ds_read_b64_tr_b16 v[62:63], v21 offset:288
    ds_read_b64_tr_b16 v[64:65], v21 offset:2048
    ds_read_b64_tr_b16 v[66:67], v21 offset:2304
    ds_read_b64_tr_b16 v[68:69], v21 offset:2080
    ds_read_b64_tr_b16 v[70:71], v21 offset:2336
    ds_read_b64_tr_b16 v[72:73], v21 offset:4096
    ds_read_b64_tr_b16 v[74:75], v21 offset:4352
    ds_read_b64_tr_b16 v[76:77], v21 offset:4128
    ds_read_b64_tr_b16 v[78:79], v21 offset:4384
    ds_read_b64_tr_b16 v[80:81], v50 offset:0
    ds_read_b64_tr_b16 v[82:83], v50 offset:256
    ds_read_b64_tr_b16 v[84:85], v50 offset:32
    ds_read_b64_tr_b16 v[86:87], v50 offset:288
    v_and_b32 v49, 7, v1
    v_lshlrev_b32 v48, 3, v16
    v_lshl_add_u32 v48, v49, 4, v48
m1_o_b:
    s_mov_b32 exec_lo, 0x00ff00ff
    s_mov_b32 exec_hi, 0x00ff00ff
    buffer_load_dwordx4 v[24:27], v48, s[56:59], s66 offen offset:0 sc1
    buffer_load_dwordx4 v[28:31], v48, s[56:59], s66 offen offset:512 sc1
    buffer_load_dwordx4 v[32:35], v48, s[56:59], s66 offen offset:1024 sc1
    buffer_load_dwordx4 v[36:39], v48, s[56:59], s66 offen offset:1536 sc1
    s_mov_b64 exec, -1
    s_sleep 1
m1_O_try:
    s_mov_b32 exec_lo, 0x00ff00ff
    s_mov_b32 exec_hi, 0x00ff00ff
    buffer_load_dwordx4 v[24:27], v48, s[56:59], s66 offen offset:0 sc1
    buffer_load_dwordx4 v[28:31], v48, s[56:59], s66 offen offset:512 sc1
    buffer_load_dwordx4 v[32:35], v48, s[56:59], s66 offen offset:1024 sc1
    buffer_load_dwordx4 v[36:39], v48, s[56:59], s66 offen offset:1536 sc1
    s_mov_b64 exec, -1
    s_waitcnt vmcnt(7) lgkmcnt(0)
    v_mfma_f32_16x16x32_bf16 v[40:43], v[24:27], v[56:59], 0
    v_mfma_f32_16x16x32_bf16 v[44:47], v[24:27], v[60:63], 0
    s_waitcnt vmcnt(6) lgkmcnt(0)
    v_mfma_f32_16x16x32_bf16 v[40:43], v[28:31], v[64:67], v[40:43]
    v_mfma_f32_16x16x32_bf16 v[44:47], v[28:31], v[68:71], v[44:47]
    s_waitcnt vmcnt(5) lgkmcnt(0)
    v_mfma_f32_16x16x32_bf16 v[40:43], v[32:35], v[72:75], v[40:43]
    v_mfma_f32_16x16x32_bf16 v[44:47], v[32:35], v[76:79], v[44:47]
    s_waitcnt vmcnt(4) lgkmcnt(0)
    v_mfma_f32_16x16x32_bf16 v[40:43], v[36:39], v[80:83], v[40:43]
    v_mfma_f32_16x16x32_bf16 v[44:47], v[36:39], v[84:87], v[44:47]
    s_nop 6
    v_pk_add_f32 v[40:41], v[40:41], v[42:43]
    v_pk_add_f32 v[44:45], v[44:45], v[46:47]
    v_add_f32 v40, v40, v41
    v_add_f32 v44, v44, v45
    s_nop 1
    v_permlane16_swap_b32 v40, v44
    v_add_f32 v40, v40, v44
    s_mov_b32 exec_hi, 0
    v_cmp_u_f32 vcc, v40, v40
    s_xor_b32 s86, s67, 8192
    s_cbranch_vccnz m1_O_rt
m1_O_ok:
    buffer_store_dword v40, v17, s[56:59], s67 offen sc1
    buffer_store_dword v40, v17, s[56:59], s86 offen sc1
    s_mov_b64 exec, -1
    s_waitcnt vmcnt(2)
    s_barrier
    s_cmp_eq_u32 s7, 2
    s_cbranch_scc0 m1_winB
    v_lshrrev_b32 v54, 3, v1
    v_mul_u32_u24 v54, 1536, v54
    v_xor_b32 v55, v2, v16
    v_and_b32 v55, 0x70, v55
    v_add_u32 v54, v54, v55
    v_xor_b32 v55, 64, v54
    s_mul_i32 s86, s3, 12288
    s_add_u32 m0, s86, 0
    s_add_u32 s87, s84, 0
    buffer_load_dwordx4 v54, s[24:27], s87 offen  lds
    s_add_u32 m0, s86, 1024
    s_add_u32 s87, s84, 12288
    buffer_load_dwordx4 v55, s[24:27], s87 offen  lds
    s_add_u32 m0, s86, 2048
    s_add_u32 s87, s84, 128
    buffer_load_dwordx4 v54, s[24:27], s87 offen  lds
    s_add_u32 m0, s86, 3072
    s_add_u32 s87, s84, 12416
    buffer_load_dwordx4 v55, s[24:27], s87 offen  lds
    s_add_u32 m0, s86, 4096
    s_add_u32 s87, s84, 256
    buffer_load_dwordx4 v54, s[24:27], s87 offen  lds
    s_add_u32 m0, s86, 5120
    s_add_u32 s87, s84, 12544
    buffer_load_dwordx4 v55, s[24:27], s87 offen  lds
    s_branch m1_next
m1_winB:
    s_cmp_eq_u32 s7, 1
    s_cbranch_scc0 m1_next
    v_lshrrev_b32 v54, 2, v1
    v_mul_u32_u24 v54, 1280, v54
    v_and_b32 v55, 3, v1
    v_lshl_add_u32 v54, v55, 4, v54
    s_mul_i32 s86, s3, 12288
    s_add_u32 m0, s86, 0
    s_add_u32 s87, s83, 0
    buffer_load_dwordx4 v54, s[20:23], s87 offen  lds
    s_add_u32 m0, s86, 1024
    s_add_u32 s87, s83, 20480
    buffer_load_dwordx4 v54, s[20:23], s87 offen  lds
    s_add_u32 m0, s86, 2048
    s_add_u32 s87, s83, 40960
    buffer_load_dwordx4 v54, s[20:23], s87 offen  lds
    s_add_u32 m0, s86, 3072
    s_add_u32 s87, s83, 61440
    buffer_load_dwordx4 v54, s[20:23], s87 offen  lds
    s_add_u32 m0, s86, 4096
    s_add_u32 s87, s83, 81920
    buffer_load_dwordx4 v54, s[20:23], s87 offen  lds
    s_add_u32 m0, s86, 5120
    s_add_u32 s87, s83, 102400
    buffer_load_dwordx4 v54, s[20:23], s87 offen  lds
    s_lshl_b32 s86, s3, 11
    s_add_u32 m0, s86, 155648
    s_add_u32 s87, s83, 122880
    buffer_load_dwordx4 v54, s[20:23], s87 offen  lds
    s_add_u32 m0, s86, 156672
    s_add_u32 s87, s83, 143360
    buffer_load_dwordx4 v54, s[20:23], s87 offen  lds
    v_mov_b32 v88, -1
    v_mov_b32 v89, -1
    v_mov_b32 v90, -1
    v_mov_b32 v91, -1
    s_lshl_b32 s87, s4, 5
    s_add_u32 s87, s87, s5
    s_lshl_b32 s87, s87, 2
    s_add_u32 s87, s87, s3
    s_lshl_b32 s87, s87, 10
    s_add_u32 s14, s87, 4653056
    s_lshr_b32 s86, s5, 4
    s_mul_i32 s86, s86, 294912
    s_and_b32 s87, s5, 15
    s_lshl_b32 s87, s87, 2
    s_add_u32 s87, s87, s3
    s_mul_i32 s87, s87, 576
    s_add_u32 s86, s86, s87
    s_mul_i32 s87, s4, 36864
    s_add_u32 s86, s86, s87
    s_add_u32 s86, s86, 5701632
    s_mov_b32 s18, s86
    s_add_u32 s30, s67, 2097152
    s_xor_b32 s38, s30, 8192
    s_and_b32 s87, s5, 15
    s_lshl_b32 s87, s87, 2
    s_add_u32 s87, s87, s3
    s_mul_i32 s87, s87, 96
    s_lshr_b32 s98, s5, 4
    s_lshl_b32 s98, s98, 13
    s_add_u32 s87, s87, s98
    s_mul_i32 s98, s4, 16640
    s_add_u32 s87, s87, s98
    s_add_u32 s87, s87, 4194304
    s_mov_b32 s34, s87
    s_and_b32 vcc_lo, s5, 7
    s_lshl_b32 vcc_lo, vcc_lo, 1
    v_add_u32 v13, vcc_lo, v23
    v_and_b32 v13, 15, v13
    v_lshlrev_b32 v13, 4, v13
    v_and_b32 v7, 3, v1
    v_lshl_add_u32 v7, v7, 10, v16
    v_add_u32 v7, 151552, v7
    s_mul_i32 vcc_lo, s3, 1280
    s_add_u32 vcc_lo, vcc_lo, 151552
    v_and_b32 v8, 0xf0, v17
    v_add_u32 v8, vcc_lo, v8
    s_mul_i32 s86, s3, 6144
    s_add_u32 s86, s86, 4294897664
    v_add_u32 v14, s86, v14
    v_add_u32 v52, s86, v5
    v_cmp_ne_u32 vcc, 151808, v5
    s_nop 1
    v_cndmask_b32 v5, v5, v52, vcc
    v_add_u32 v52, s86, v6
    v_cmp_ne_u32 vcc, 151808, v6
    s_nop 1
    v_cndmask_b32 v6, v6, v52, vcc
    v_mov_b32 v48, 0
    v_mov_b32 v49, 0
    v_mov_b32 v50, 0
    v_mov_b32 v51, 0
    s_lshl_b32 s86, s3, 10
    s_add_u32 s86, s86, 151552
    v_add_u32 v52, s86, v2
    ds_write_b128 v52, v[48:51]
m1_next:
m1_E:
    s_cmp_ge_u32 s0, 20
    s_nop 0
    s_cbranch_scc1 m1_noE
    s_xor_b32 s86, s0, s4
    s_and_b32 s86, s86, 7
    s_cselect_b32 s86, s7, 0
    s_cmp_eq_u32 s86, 3
    s_cbranch_scc1 m1_done
    s_sleep 2
    s_add_u32 s86, s68, 4096
    v_lshrrev_b32 v51, 2, v16
    buffer_load_dwordx4 v[24:27], v2, s[56:59], s68 offen offset:0 sc1
    buffer_load_dwordx4 v[28:31], v2, s[56:59], s68 offen offset:1024 sc1
    buffer_load_dwordx4 v[32:35], v2, s[56:59], s68 offen offset:2048 sc1
    buffer_load_dwordx4 v[36:39], v2, s[56:59], s68 offen offset:3072 sc1
    buffer_load_dwordx4 v[40:43], v2, s[56:59], s86 offen offset:0 sc1
    buffer_load_dwordx4 v[44:47], v2, s[56:59], s86 offen offset:1024 sc1
    s_sleep 6
m1_E_try:
    buffer_load_dwordx4 v[56:59], v2, s[56:59], s68 offen offset:0 sc1
    buffer_load_dwordx4 v[60:63], v2, s[56:59], s68 offen offset:1024 sc1
    buffer_load_dwordx4 v[64:67], v2, s[56:59], s68 offen offset:2048 sc1
    buffer_load_dwordx4 v[68:71], v2, s[56:59], s68 offen offset:3072 sc1
    buffer_load_dwordx4 v[72:75], v2, s[56:59], s86 offen offset:0 sc1
    buffer_load_dwordx4 v[76:79], v2, s[56:59], s86 offen offset:1024 sc1
    s_waitcnt vmcnt(10)
    v_pk_add_f32 v[24:25], v[24:25], v[28:29]
    v_pk_add_f32 v[26:27], v[26:27], v[30:31]
    s_waitcnt vmcnt(9)
    v_pk_add_f32 v[24:25], v[24:25], v[32:33]
    v_pk_add_f32 v[26:27], v[26:27], v[34:35]
    s_waitcnt vmcnt(8)
    v_pk_add_f32 v[24:25], v[24:25], v[36:37]
    v_pk_add_f32 v[26:27], v[26:27], v[38:39]
    s_waitcnt vmcnt(7)
    v_pk_add_f32 v[24:25], v[24:25], v[40:41]
    v_pk_add_f32 v[26:27], v[26:27], v[42:43]
    s_waitcnt vmcnt(6)
    v_pk_add_f32 v[24:25], v[24:25], v[44:45]
    v_pk_add_f32 v[26:27], v[26:27], v[46:47]
    s_nop 0
    v_permlane16_swap_b32 v24, v25
    v_permlane16_swap_b32 v26, v27
    v_add_f32 v24, v24, v25
    v_add_f32 v26, v26, v27
    s_nop 1
    v_permlane32_swap_b32 v24, v26
    v_add_f32 v24, v24, v26
    v_add_f32 v48, v24, v19
    s_nop 0
    v_add_f32_dpp v48, v24, v48 row_ror:8 row_mask:0xf bank_mask:0xf
    v_cmp_u_f32 vcc, v48, v48
    v_cvt_pk_bf16_f32 v48, v48, v48
    s_cbranch_vccz m1_E_ok
    buffer_load_dwordx4 v[24:27], v2, s[56:59], s68 offen offset:0 sc1
    buffer_load_dwordx4 v[28:31], v2, s[56:59], s68 offen offset:1024 sc1
    buffer_load_dwordx4 v[32:35], v2, s[56:59], s68 offen offset:2048 sc1
    buffer_load_dwordx4 v[36:39], v2, s[56:59], s68 offen offset:3072 sc1
    buffer_load_dwordx4 v[40:43], v2, s[56:59], s86 offen offset:0 sc1
    buffer_load_dwordx4 v[44:47], v2, s[56:59], s86 offen offset:1024 sc1
    s_waitcnt vmcnt(10)
    v_pk_add_f32 v[56:57], v[56:57], v[60:61]
    v_pk_add_f32 v[58:59], v[58:59], v[62:63]
    s_waitcnt vmcnt(9)
    v_pk_add_f32 v[56:57], v[56:57], v[64:65]
    v_pk_add_f32 v[58:59], v[58:59], v[66:67]
    s_waitcnt vmcnt(8)
    v_pk_add_f32 v[56:57], v[56:57], v[68:69]
    v_pk_add_f32 v[58:59], v[58:59], v[70:71]
    s_waitcnt vmcnt(7)
    v_pk_add_f32 v[56:57], v[56:57], v[72:73]
    v_pk_add_f32 v[58:59], v[58:59], v[74:75]
    s_waitcnt vmcnt(6)
    v_pk_add_f32 v[56:57], v[56:57], v[76:77]
    v_pk_add_f32 v[58:59], v[58:59], v[78:79]
    s_nop 0
    v_permlane16_swap_b32 v56, v57
    v_permlane16_swap_b32 v58, v59
    v_add_f32 v56, v56, v57
    v_add_f32 v58, v58, v59
    s_nop 1
    v_permlane32_swap_b32 v56, v58
    v_add_f32 v56, v56, v58
    v_add_f32 v48, v56, v19
    s_nop 0
    v_add_f32_dpp v48, v56, v48 row_ror:8 row_mask:0xf bank_mask:0xf
    v_cmp_u_f32 vcc, v48, v48
    v_cvt_pk_bf16_f32 v48, v48, v48
    s_cbranch_vccnz m1_E_rt
m1_E_ok:
    s_mov_b32 exec_lo, 0x00ff00ff
    s_mov_b32 exec_hi, 0x00ff00ff
    s_cmp_eq_u32 s7, 3
    s_cbranch_scc1 m1_final
    buffer_store_short v48, v20, s[56:59], s69 offen sc1
    s_mov_b64 exec, -1
    v_and_b32 v49, 0xffff0000, v48
    v_and_b32 v19, 0xffff0000, v48
    v_mul_f32 v50, v49, v49
    s_nop 1
    v_permlane16_swap_b32 v49, v50
    v_add_f32 v49, v49, v50
    v_mov_b32 v50, v49
    s_nop 1
    v_permlane32_swap_b32 v49, v50
    v_add_f32 v49, v49, v50
    s_nop 1
    v_add_f32_dpp v49, v49, v49 row_ror:4 row_mask:0xf bank_mask:0xf
    s_nop 1
    v_add_f32_dpp v49, v49, v49 row_ror:2 row_mask:0xf bank_mask:0xf
    s_nop 1
    v_add_f32_dpp v49, v49, v49 row_ror:1 row_mask:0xf bank_mask:0xf
    s_mov_b64 exec, 0x10001
    buffer_store_dword v49, v51, s[56:59], s71 offen sc1
    s_mov_b64 exec, -1
    s_waitcnt vmcnt(2)
m1_noE:
    s_lshr_b32 s86, s10, s7
    s_and_b32 s86, s86, 1
    s_lshl_b32 s86, s86, 13
    s_xor_b32 s68, s68, s86
    s_xor_b32 s74, s74, s86
    s_xor_b32 s79, s79, s86
    s_xor_b32 s80, s80, s86
    s_xor_b32 s67, s67, s86
    s_xor_b32 s73, s73, s86
    s_add_u32 s7, s7, 1
    s_add_u32 s56, s56, 2097152
    s_addc_u32 s57, s57, 0
    s_cmp_eq_u32 s7, 4
    s_cbranch_scc0 m1_layer
    s_branch m1_done
m1_layerB:
    s_waitcnt lgkmcnt(5)
    v_mfma_f32_16x16x32_bf16 v[28:31], a[216:219], v[32:35], 0
    v_mfma_f32_16x16x32_bf16 v[24:27], a[192:195], v[32:35], 0
    s_waitcnt lgkmcnt(4)
    v_mfma_f32_16x16x32_bf16 v[28:31], a[220:223], v[36:39], v[28:31]
    v_mfma_f32_16x16x32_bf16 v[24:27], a[196:199], v[36:39], v[24:27]
    s_waitcnt lgkmcnt(3)
    v_mfma_f32_16x16x32_bf16 v[28:31], a[224:227], v[40:43], v[28:31]
    v_mfma_f32_16x16x32_bf16 v[24:27], a[200:203], v[40:43], v[24:27]
    s_waitcnt lgkmcnt(2)
    v_mfma_f32_16x16x32_bf16 v[24:27], a[204:207], v[44:47], v[24:27]
    s_waitcnt lgkmcnt(1)
    v_mfma_f32_16x16x32_bf16 v[24:27], a[208:211], v[48:51], v[24:27]
    s_waitcnt lgkmcnt(0)
    v_mfma_f32_16x16x32_bf16 v[24:27], a[212:215], v[52:55], v[24:27]
    s_mov_b32 s86, 0x3dd53b95
    s_xor_b32 s87, s73, 8192
    v_mov_b32_dpp v33, v28 quad_perm:[0,0,0,0] row_mask:0xf bank_mask:0xf
    v_add_f32_dpp v33, v29, v33 quad_perm:[1,1,1,1] row_mask:0xf bank_mask:0xf
    v_add_f32_dpp v33, v30, v33 quad_perm:[2,2,2,2] row_mask:0xf bank_mask:0xf
    v_add_f32_dpp v33, v31, v33 quad_perm:[3,3,3,3] row_mask:0xf bank_mask:0xf
    v_mul_f32 v33, s86, v33
    s_nop 1
    v_mov_b32_dpp v35, v33 row_shl:4 row_mask:0xf bank_mask:0xf
    v_cvt_pk_bf16_f32 v33, v33, v35
    v_mov_b32_dpp v32, v24 quad_perm:[0,0,0,0] row_mask:0xf bank_mask:0xf
    v_add_f32_dpp v32, v25, v32 quad_perm:[1,1,1,1] row_mask:0xf bank_mask:0xf
    v_add_f32_dpp v32, v26, v32 quad_perm:[2,2,2,2] row_mask:0xf bank_mask:0xf
    v_add_f32_dpp v32, v27, v32 quad_perm:[3,3,3,3] row_mask:0xf bank_mask:0xf
    v_mul_f32 v32, s86, v32
    s_nop 1
    v_mov_b32_dpp v34, v32 row_shl:4 row_mask:0xf bank_mask:0xf
    v_cvt_pk_bf16_f32 v32, v32, v34
    v_cndmask_b32 v32, v32, v33, s[100:101]
    s_mov_b64 exec, s[94:95]
    buffer_store_dword v32, v15, s[56:59], s73 offen sc1
    buffer_store_dword v32, v15, s[56:59], s87 offen sc1
    s_mov_b64 exec, -1
    s_barrier
    s_cmp_lg_u32 s7, 1
    s_cbranch_scc1 m1_noql
    s_lshl_b32 s86, s5, 2
    s_add_u32 s86, s86, s3
    s_cmp_lt_u32 s86, 108
    s_cselect_b32 s98, 0, 0x40000000
    s_mul_i32 s86, s86, 9216
    s_mul_i32 s87, s4, 983040
    s_add_u32 s86, s86, s87
    s_lshl_b32 s87, s3, 11
    s_add_u32 m0, s87, 156672
    v_lshlrev_b32 v29, 7, v1
    v_or_b32 v29, s98, v29
    s_mov_b32 exec_lo, 0xffffffff
    s_mov_b32 exec_hi, 0xf
    buffer_load_dword v29, s[40:43], s86 offen lds
    s_mov_b64 exec, -1
    s_lshr_b32 s86, s5, 4
    s_mul_i32 s86, s86, 2097152
    s_and_b32 s87, s5, 15
    s_lshl_b32 s87, s87, 2
    s_add_u32 s87, s87, s3
    s_mul_i32 s87, s87, 576
    s_add_u32 s86, s86, s87
    s_mul_i32 s87, s4, 36864
    s_add_u32 s86, s86, s87
    s_add_u32 s86, s86, 5701632
    s_lshl_b32 s87, s3, 11
    s_add_u32 m0, s87, 156672
    v_lshlrev_b32 v89, 6, v1
    s_mov_b64 exec, 0x1ff
    buffer_load_dword v89, s[56:59], s86 offen sc1 lds
    s_mov_b64 exec, -1
m1_noql:
    s_mov_b32 s98, s74
    s_add_u32 s86, s74, 66560
    v_xor_b32 v7, 64, v4
    s_and_b32 s87, s3, 1
    s_lshl_b32 s87, s87, 3
    v_lshrrev_b32 v48, 3, v1
    v_add_u32 v48, s87, v48
    v_and_b32 v49, 6, v1
    v_lshlrev_b32 v50, 1, v49
    v_xor_b32 v48, v48, v50
    v_lshlrev_b32 v48, 4, v48
    v_lshl_add_u32 v48, v49, 7, v48
    v_and_b32 v49, 1, v1
    v_lshl_add_u32 v48, v49, 3, v48
    s_lshr_b32 s87, s3, 1
    s_lshl_b32 s87, s87, 10
    s_add_u32 s87, s87, 155648
    v_add_u32 v8, s87, v48
    s_sleep 10
m1_S_try:
    buffer_load_dwordx4 v[24:27], v3, s[56:59], s98 offen offset:0 sc1
    buffer_load_dwordx4 v[56:59], v3, s[56:59], s86 offen offset:0 sc1
    buffer_load_dwordx4 v[28:31], v3, s[56:59], s98 offen offset:256 sc1
    buffer_load_dwordx4 v[60:63], v3, s[56:59], s86 offen offset:256 sc1
    buffer_load_dwordx4 v[32:35], v3, s[56:59], s98 offen offset:512 sc1
    buffer_load_dwordx4 v[64:67], v3, s[56:59], s86 offen offset:512 sc1
    buffer_load_dwordx4 v[36:39], v3, s[56:59], s98 offen offset:768 sc1
    buffer_load_dwordx4 v[68:71], v3, s[56:59], s86 offen offset:768 sc1
    buffer_load_dwordx4 v[40:43], v3, s[56:59], s98 offen offset:1024 sc1
    buffer_load_dwordx4 v[72:75], v3, s[56:59], s86 offen offset:1024 sc1
    buffer_load_dwordx4 v[44:47], v3, s[56:59], s98 offen offset:1280 sc1
    buffer_load_dwordx4 v[76:79], v3, s[56:59], s86 offen offset:1280 sc1
    ds_read_b128 v[80:83], v4 offset:0
    ds_read_b128 v[84:87], v7 offset:0
    ds_read_b128 v[88:91], v4 offset:2048
    s_waitcnt vmcnt(11) lgkmcnt(0)
    v_mfma_f32_16x16x32_bf16 v[48:51], v[80:83], v[24:27], 0
    s_waitcnt vmcnt(10)
    v_mfma_f32_16x16x32_bf16 v[52:55], v[80:83], v[56:59], 0
    ds_read_b128 v[80:83], v7 offset:2048
    s_waitcnt vmcnt(9)
    v_mfma_f32_16x16x32_bf16 v[48:51], v[84:87], v[28:31], v[48:51]
    s_waitcnt vmcnt(8)
    v_mfma_f32_16x16x32_bf16 v[52:55], v[84:87], v[60:63], v[52:55]
    ds_read_b128 v[84:87], v4 offset:4096
    s_waitcnt vmcnt(7)
    v_mfma_f32_16x16x32_bf16 v[48:51], v[88:91], v[32:35], v[48:51]
    s_waitcnt vmcnt(6)
    v_mfma_f32_16x16x32_bf16 v[52:55], v[88:91], v[64:67], v[52:55]
    ds_read_b128 v[88:91], v7 offset:4096
    s_waitcnt vmcnt(5) lgkmcnt(2)
    v_mfma_f32_16x16x32_bf16 v[48:51], v[80:83], v[36:39], v[48:51]
    s_waitcnt vmcnt(4)
    v_mfma_f32_16x16x32_bf16 v[52:55], v[80:83], v[68:71], v[52:55]
    s_waitcnt vmcnt(3) lgkmcnt(1)
    v_mfma_f32_16x16x32_bf16 v[48:51], v[84:87], v[40:43], v[48:51]
    s_waitcnt vmcnt(2)
    v_mfma_f32_16x16x32_bf16 v[52:55], v[84:87], v[72:75], v[52:55]
    s_waitcnt vmcnt(1) lgkmcnt(0)
    v_mfma_f32_16x16x32_bf16 v[48:51], v[88:91], v[44:47], v[48:51]
    s_waitcnt vmcnt(0)
    v_mfma_f32_16x16x32_bf16 v[52:55], v[88:91], v[76:79], v[52:55]
    v_lshlrev_b32 v34, 1, v1
    s_nop 6
    v_cmp_u_f32 vcc, v48, v52
    s_cbranch_vccnz m1_S_rt
m1_S_ok:
    ds_write_b128 v22, v[48:51]
    ds_write_b128 v22, v[52:55] offset:1024
    ds_read_b64_tr_b16 v[56:57], v10 offset:0
    ds_read_b64_tr_b16 v[58:59], v10 offset:384
    ds_read_b64_tr_b16 v[60:61], v10 offset:32
    ds_read_b64_tr_b16 v[62:63], v10 offset:416
    ds_read_b64_tr_b16 v[64:65], v10 offset:64
    ds_read_b64_tr_b16 v[66:67], v10 offset:448
    ds_read_b64_tr_b16 v[68:69], v10 offset:768
    ds_read_b64_tr_b16 v[70:71], v10 offset:1152
    ds_read_b64_tr_b16 v[72:73], v10 offset:800
    ds_read_b64_tr_b16 v[74:75], v10 offset:1184
    ds_read_b64_tr_b16 v[76:77], v10 offset:832
    ds_read_b64_tr_b16 v[78:79], v10 offset:1216
    s_waitcnt lgkmcnt(12)
    s_barrier
    ds_read_b64 v[24:25], v8 offset:0
    ds_read_b64 v[26:27], v8 offset:2048
    ds_read_b64 v[28:29], v8 offset:4096
    ds_read_b64 v[30:31], v8 offset:6144
    s_waitcnt lgkmcnt(2)
    v_pk_add_f32 v[24:25], v[24:25], v[26:27]
    s_waitcnt lgkmcnt(0)
    v_pk_add_f32 v[28:29], v[28:29], v[30:31]
    v_pk_add_f32 v[24:25], v[24:25], v[28:29]
    v_max_f32 v32, v24, v25
    s_nop 1
    v_max_f32_dpp v32, v32, v32 quad_perm:[1,0,3,2] row_mask:0xf bank_mask:0xf
    s_nop 1
    v_max_f32_dpp v32, v32, v32 quad_perm:[2,3,0,1] row_mask:0xf bank_mask:0xf
    s_nop 1
    v_max_f32_dpp v32, v32, v32 row_half_mirror row_mask:0xf bank_mask:0xf
    v_ceil_f32 v32, v32
    v_sub_f32 v24, v24, v32
    v_sub_f32 v25, v25, v32
    v_mul_f32 v33, 0x43000000, v32
    v_exp_f32 v24, v24
    v_exp_f32 v25, v25
    s_mov_b64 exec, s[92:93]
    buffer_store_dword v33, v34, s[56:59], s75 offen sc1
    s_mov_b64 exec, -1
    v_cvt_pk_bf16_f32 v24, v24, v25
    buffer_store_dword v24, v11, s[56:59], s81 offen sc1
    ds_read_b64_tr_b16 v[80:81], v10 offset:12288
    ds_read_b64_tr_b16 v[82:83], v10 offset:12672
    ds_read_b64_tr_b16 v[84:85], v10 offset:12320
    ds_read_b64_tr_b16 v[86:87], v10 offset:12704
    v_mov_b32 v88, 0x3f803f80
    v_mov_b32 v89, 0x3f803f80
    v_mov_b32 v90, 0x3f803f80
    v_mov_b32 v91, 0x3f803f80
    s_and_b32 s87, s3, 1
    s_lshl_b32 s87, s87, 3
    s_add_u32 s87, s87, s76
    s_mul_i32 s86, s3, 12288
    v_and_b32 v13, 32, v1
    v_xor_b32 v13, v13, v2
    v_add_u32 v13, s86, v13
    s_sleep 5
m1_R_go:
    buffer_load_dwordx4 v[40:43], v2, s[56:59], s76 offen sc1
    buffer_load_dwordx2 v[44:45], v2, s[56:59], s87 offen sc1
    buffer_load_dwordx4 v[24:27], v2, s[56:59], s82 offen offset:0 sc1
    buffer_load_dwordx4 v[28:31], v2, s[56:59], s82 offen offset:1024 sc1
    buffer_load_dwordx4 v[32:35], v2, s[56:59], s82 offen offset:2048 sc1
    buffer_load_dwordx4 v[36:39], v2, s[56:59], s82 offen offset:3072 sc1
    s_waitcnt vmcnt(5)
    v_maximum3_f32 v40, v40, v41, v42
    v_maximum3_f32 v41, v40, v43, v43
    v_maximum3_f32 v40, v40, v43, v43
    s_waitcnt vmcnt(3)
    v_or3_b32 v7, v24, v25, v26
    v_permlane16_swap_b32 v40, v41
    v_maximum3_f32 v42, v40, v41, v41
    v_maximum3_f32 v40, v40, v41, v41
    s_waitcnt vmcnt(2)
    v_or3_b32 v7, v7, v27, v28
    v_permlane32_swap_b32 v40, v42
    v_maximum3_f32 v8, v40, v42, v42
    v_sub_f32 v54, v8, v44
    v_sub_f32 v55, v8, v45
    v_or3_b32 v7, v7, v29, v30
    v_cvt_u32_f32 v54, v54
    v_cvt_u32_f32 v55, v55
    s_waitcnt vmcnt(1)
    v_or3_b32 v7, v7, v31, v32
    v_min_u32 v54, 0x7fff, v54
    v_min_u32 v55, 0x7fff, v55
    v_pk_sub_u16 v24, v24, v54 op_sel_hi:[1,0] clamp
    v_pk_sub_u16 v25, v25, v54 op_sel_hi:[1,0] clamp
    v_pk_sub_u16 v26, v26, v54 op_sel_hi:[1,0] clamp
    v_pk_sub_u16 v27, v27, v54 op_sel_hi:[1,0] clamp
    s_waitcnt lgkmcnt(0)
    v_pk_sub_u16 v28, v28, v54 op_sel_hi:[1,0] clamp
    v_pk_sub_u16 v29, v29, v54 op_sel_hi:[1,0] clamp
    v_mfma_f32_16x16x32_bf16 v[40:43], v[56:59], v[24:27], 0
    v_pk_sub_u16 v30, v30, v54 op_sel_hi:[1,0] clamp
    v_pk_sub_u16 v31, v31, v54 op_sel_hi:[1,0] clamp
    v_mfma_f32_16x16x32_bf16 v[44:47], v[60:63], v[24:27], 0
    v_or3_b32 v7, v7, v33, v34
    s_waitcnt vmcnt(0)
    v_mfma_f32_16x16x32_bf16 v[48:51], v[64:67], v[24:27], 0
    v_or3_b32 v7, v7, v35, v36
    v_pk_sub_u16 v32, v32, v55 op_sel_hi:[1,0] clamp
    v_pk_sub_u16 v33, v33, v55 op_sel_hi:[1,0] clamp
    v_mfma_f32_16x16x32_bf16 v[40:43], v[68:71], v[28:31], v[40:43]
    ds_read_b64_tr_b16 v[56:57], v10 offset:12352
    ds_read_b64_tr_b16 v[58:59], v10 offset:12736
    ds_read_b64_tr_b16 v[60:61], v10 offset:13056
    ds_read_b64_tr_b16 v[62:63], v10 offset:13440
    ds_read_b64_tr_b16 v[64:65], v10 offset:13088
    ds_read_b64_tr_b16 v[66:67], v10 offset:13472
    ds_read_b64_tr_b16 v[68:69], v10 offset:13120
    ds_read_b64_tr_b16 v[70:71], v10 offset:13504
    v_pk_sub_u16 v34, v34, v55 op_sel_hi:[1,0] clamp
    v_pk_sub_u16 v35, v35, v55 op_sel_hi:[1,0] clamp
    v_mfma_f32_16x16x32_bf16 v[44:47], v[72:75], v[28:31], v[44:47]
    v_or3_b32 v7, v7, v37, v38
    v_or_b32 v7, v7, v39
    v_mfma_f32_16x16x32_bf16 v[48:51], v[76:79], v[28:31], v[48:51]
    v_pk_sub_u16 v36, v36, v55 op_sel_hi:[1,0] clamp
    v_pk_sub_u16 v37, v37, v55 op_sel_hi:[1,0] clamp
    v_mfma_f32_16x16x32_bf16 v[40:43], v[80:83], v[32:35], v[40:43]
    v_pk_sub_u16 v38, v38, v55 op_sel_hi:[1,0] clamp
    v_pk_sub_u16 v39, v39, v55 op_sel_hi:[1,0] clamp
    v_mfma_f32_16x16x32_bf16 v[44:47], v[84:87], v[32:35], v[44:47]
    s_waitcnt lgkmcnt(0)
    v_and_b32 v7, 0x80008000, v7
    v_cmp_ne_u32 vcc, 0, v7
    v_mfma_f32_16x16x32_bf16 v[48:51], v[56:59], v[32:35], v[48:51]
    v_cmp_u_f32 s[98:99], v8, v8
    v_mfma_f32_16x16x32_bf16 v[40:43], v[60:63], v[36:39], v[40:43]
    v_mfma_f32_16x16x32_bf16 v[44:47], v[64:67], v[36:39], v[44:47]
    v_mfma_f32_16x16x32_bf16 v[48:51], v[68:71], v[36:39], v[48:51]
    v_mfma_f32_16x16x32_bf16 v[52:55], v[88:91], v[24:27], 0
    v_xor_b32 v56, 64, v13
    v_mfma_f32_16x16x32_bf16 v[52:55], v[88:91], v[28:31], v[52:55]
    v_xor_b32 v57, 128, v13
    v_mfma_f32_16x16x32_bf16 v[52:55], v[88:91], v[32:35], v[52:55]
    v_xor_b32 v58, 192, v13
    v_mfma_f32_16x16x32_bf16 v[52:55], v[88:91], v[36:39], v[52:55]
    s_or_b64 vcc, vcc, s[98:99]
    s_cbranch_vccnz m1_R_rt
m1_R_ok:
    ds_write_b128 v13, v[40:43]
    ds_write_b128 v56, v[44:47] offset:1024
    ds_write_b128 v57, v[48:51] offset:2048
    s_mov_b32 exec_lo, 0xffff0000
    s_mov_b32 exec_hi, 0
    s_nop 0
    v_mul_f32 v52, 0x3b800000, v8
    s_mov_b64 exec, -1
    ds_write_b128 v58, v[52:55] offset:3072
    v_and_b32 v60, 32, v1
    v_and_b32 v61, 0x1f0, v2
    v_lshl_add_u32 v60, v60, 13, v61
    s_mov_b32 vcc_lo, 0x40404040
    s_mov_b32 vcc_hi, 0x40404040
    s_waitcnt lgkmcnt(0)
    s_barrier
    ds_read_b128 v[24:27], v12 offset:0
    ds_read_b128 v[32:35], v12 offset:12288
    ds_read_b128 v[28:31], v12 offset:256
    ds_read_b128 v[36:39], v12 offset:12544
    s_waitcnt lgkmcnt(2)
    v_pk_add_f32 v[24:25], v[24:25], v[32:33]
    v_pk_add_f32 v[26:27], v[26:27], v[34:35]
    v_cvt_pk_bf16_f32 v40, v24, v25
    v_cvt_pk_bf16_f32 v41, v26, v27
    v_cndmask_b32 v41, v41, v24, vcc
    s_waitcnt lgkmcnt(0)
    v_pk_add_f32 v[28:29], v[28:29], v[36:37]
    v_pk_add_f32 v[30:31], v[30:31], v[38:39]
    v_cvt_pk_bf16_f32 v42, v28, v29
    v_cvt_pk_bf16_f32 v43, v30, v31
    v_cndmask_b32 v40, v40, v28, vcc
    buffer_store_dwordx4 v[40:43], v60, s[56:59], s79 offen sc1
    s_barrier
    v_lshrrev_b32 v54, 2, v1
    v_mul_u32_u24 v54, 1280, v54
    v_and_b32 v55, 3, v1
    v_lshl_add_u32 v54, v55, 4, v54
    s_mul_i32 s86, s3, 12288
    s_add_u32 m0, s86, 0
    s_add_u32 s87, s83, 0
    buffer_load_dwordx4 v54, s[40:43], s87 offen  lds
    s_add_u32 m0, s86, 1024
    s_add_u32 s87, s83, 20480
    buffer_load_dwordx4 v54, s[40:43], s87 offen  lds
    s_add_u32 m0, s86, 2048
    s_add_u32 s87, s83, 40960
    buffer_load_dwordx4 v54, s[40:43], s87 offen  lds
    s_add_u32 m0, s86, 3072
    s_add_u32 s87, s83, 61440
    buffer_load_dwordx4 v54, s[40:43], s87 offen  lds
    s_add_u32 m0, s86, 4096
    s_add_u32 s87, s83, 81920
    buffer_load_dwordx4 v54, s[40:43], s87 offen  lds
    s_add_u32 m0, s86, 5120
    s_add_u32 s87, s83, 102400
    buffer_load_dwordx4 v54, s[40:43], s87 offen  lds
    s_lshl_b32 s86, s3, 11
    s_add_u32 m0, s86, 155648
    s_add_u32 s87, s83, 122880
    buffer_load_dwordx4 v54, s[40:43], s87 offen  lds
    s_add_u32 m0, s86, 156672
    s_add_u32 s87, s83, 143360
    buffer_load_dwordx4 v54, s[40:43], s87 offen  lds
    v_lshrrev_b32 v52, 3, v1
    v_and_b32 v53, 0x70, v2
    v_lshl_add_u32 v52, v52, 15, v53
    buffer_load_dwordx4 v[48:51], v52, s[56:59], s80 offen sc1
    v_lshrrev_b32 v55, 4, v1
    v_mul_u32_u24 v55, 24, v55
    v_bfe_u32 v54, v1, 2, 2
    v_add_u32 v55, v55, v54
    v_mul_u32_u24 v55, 384, v55
    v_and_b32 v54, 3, v1
    v_lshl_add_u32 v55, v54, 3, v55
    s_mul_i32 s86, s3, 96
    s_add_u32 s86, s86, 49152
    v_add_u32 v55, s86, v55
    ds_read_b64_tr_b16 v[56:57], v55 offset:0
    ds_read_b64_tr_b16 v[58:59], v55 offset:1536
    ds_read_b64_tr_b16 v[60:61], v55 offset:32
    ds_read_b64_tr_b16 v[62:63], v55 offset:1568
    ds_read_b64_tr_b16 v[64:65], v55 offset:64
    ds_read_b64_tr_b16 v[66:67], v55 offset:1600
    ds_read_b64_tr_b16 v[68:69], v55 offset:3072
    ds_read_b64_tr_b16 v[70:71], v55 offset:4608
    ds_read_b64_tr_b16 v[72:73], v55 offset:3104
    ds_read_b64_tr_b16 v[74:75], v55 offset:4640
    ds_read_b64_tr_b16 v[76:77], v55 offset:3136
    ds_read_b64_tr_b16 v[78:79], v55 offset:4672
    ds_read_b64_tr_b16 v[80:81], v55 offset:6144
    ds_read_b64_tr_b16 v[82:83], v55 offset:7680
    ds_read_b64_tr_b16 v[84:85], v55 offset:6176
    ds_read_b64_tr_b16 v[86:87], v55 offset:7712
    ds_read_b64_tr_b16 v[88:89], v55 offset:6208
    ds_read_b64_tr_b16 v[90:91], v55 offset:7744
    v_lshrrev_b32 v54, 3, v1
    v_lshlrev_b32 v54, 4, v54
    v_xor_b32 v54, v54, v2
    s_lshl_b32 s86, s3, 10
    s_add_u32 s86, s86, 151552
    v_add_u32 v54, s86, v54
    v_and_b32 v36, 32, v1
    v_lshlrev_b32 v36, 6, v36
    v_lshl_add_u32 v36, v23, 7, v36
    v_add_u32 v36, 151552, v36
    v_and_b32 v37, 16, v1
    v_mul_u32_u24 v37, 3, v37
    v_add_u32 v24, 0, v37
    v_xor_b32 v24, v24, v53
    v_add_u32 v24, v24, v36
    v_add_u32 v28, 16, v37
    v_xor_b32 v28, v28, v53
    v_add_u32 v28, v28, v36
    v_add_u32 v32, 32, v37
    v_xor_b32 v32, v32, v53
    v_add_u32 v32, v32, v36
    v_lshrrev_b32 v53, 2, v16
    v_add_u32 v53, v53, v23
    v_and_b32 v53, 15, v53
    v_xor_b32 v36, 6, v53
    v_and_b32 v36, 7, v36
    v_lshlrev_b32 v53, 7, v53
    v_lshl_add_u32 v53, v36, 4, v53
    v_add_u32 v53, 151552, v53
m1_UV_w:
    s_waitcnt vmcnt(0)
    ds_write_b128 v54, v[48:51]
    v_max3_u32 v55, v48, v49, v50
    v_max_u32 v55, v55, v51
    v_cmp_eq_u32 vcc, -1, v55
    s_cbranch_vccnz m1_UV_rt
m1_UV_ok:
    s_waitcnt lgkmcnt(0)
    s_barrier
    ds_read_b64 v[48:49], v53
    ds_read_b128 v[24:27], v24
    ds_read_b128 v[28:31], v28
    ds_read_b128 v[32:35], v32
    s_waitcnt lgkmcnt(3)
    v_max_f32_dpp v50, v48, v48 row_ror:8 row_mask:0xf bank_mask:0xf
    s_waitcnt lgkmcnt(2)
    v_mfma_f32_16x16x32_bf16 v[36:39], v[24:27], v[56:59], 0
    v_max_f32_dpp v50, v50, v50 row_ror:4 row_mask:0xf bank_mask:0xf
    v_mfma_f32_16x16x32_bf16 v[40:43], v[24:27], v[60:63], 0
    v_mfma_f32_16x16x32_bf16 v[44:47], v[24:27], v[64:67], 0
    v_max_f32_dpp v50, v50, v50 row_ror:2 row_mask:0xf bank_mask:0xf
    s_waitcnt lgkmcnt(1)
    v_mfma_f32_16x16x32_bf16 v[36:39], v[28:31], v[68:71], v[36:39]
    v_mfma_f32_16x16x32_bf16 v[40:43], v[28:31], v[72:75], v[40:43]
    v_max_f32_dpp v50, v50, v50 row_ror:1 row_mask:0xf bank_mask:0xf
    v_mfma_f32_16x16x32_bf16 v[44:47], v[28:31], v[76:79], v[44:47]
    v_sub_f32 v51, v48, v50
    s_waitcnt lgkmcnt(0)
    v_mfma_f32_16x16x32_bf16 v[36:39], v[32:35], v[80:83], v[36:39]
    v_exp_f32 v51, v51
    v_mfma_f32_16x16x32_bf16 v[40:43], v[32:35], v[84:87], v[40:43]
    v_mul_f32 v52, v51, v49
    v_mfma_f32_16x16x32_bf16 v[44:47], v[32:35], v[88:91], v[44:47]
    s_nop 0
    v_add_f32_dpp v52, v52, v52 row_ror:8 row_mask:0xf bank_mask:0xf
    s_nop 1
    v_add_f32_dpp v52, v52, v52 row_ror:4 row_mask:0xf bank_mask:0xf
    s_nop 1
    v_add_f32_dpp v52, v52, v52 row_ror:2 row_mask:0xf bank_mask:0xf
    v_mul_f32_dpp v24, v51, v36 row_newbcast:0 row_mask:0xf bank_mask:0xf
    v_mul_f32_dpp v25, v51, v40 row_newbcast:0 row_mask:0xf bank_mask:0xf
    v_mul_f32_dpp v26, v51, v44 row_newbcast:0 row_mask:0xf bank_mask:0xf
    v_add_f32_dpp v52, v52, v52 row_ror:1 row_mask:0xf bank_mask:0xf
    v_fmac_f32_dpp v24, v51, v37 row_newbcast:1 row_mask:0xf bank_mask:0xf
    v_fmac_f32_dpp v25, v51, v41 row_newbcast:1 row_mask:0xf bank_mask:0xf
    v_fmac_f32_dpp v26, v51, v45 row_newbcast:1 row_mask:0xf bank_mask:0xf
    v_rcp_f32 v52, v52
    v_fmac_f32_dpp v24, v51, v38 row_newbcast:2 row_mask:0xf bank_mask:0xf
    v_fmac_f32_dpp v25, v51, v42 row_newbcast:2 row_mask:0xf bank_mask:0xf
    v_fmac_f32_dpp v26, v51, v46 row_newbcast:2 row_mask:0xf bank_mask:0xf
    v_fmac_f32_dpp v24, v51, v39 row_newbcast:3 row_mask:0xf bank_mask:0xf
    v_fmac_f32_dpp v25, v51, v43 row_newbcast:3 row_mask:0xf bank_mask:0xf
    v_fmac_f32_dpp v26, v51, v47 row_newbcast:3 row_mask:0xf bank_mask:0xf
    v_mov_b32 v27, v26
    v_permlane16_swap_b32 v24, v25
    v_add_f32 v24, v24, v25
    v_permlane16_swap_b32 v26, v27
    v_add_f32 v26, v26, v27
    s_nop 1
    v_permlane32_swap_b32 v24, v26
    v_add_f32 v24, v24, v26
    v_mul_f32 v24, v24, v52
    s_nop 1
    v_mov_b32_dpp v25, v24 row_shl:1 row_mask:0xf bank_mask:0xf
    v_cvt_pk_bf16_f32 v24, v24, v25
    s_mov_b64 exec, s[90:91]
    buffer_store_dword v24, v18, s[56:59], s65 offen sc1
    s_mov_b64 exec, -1
    s_branch m1_O
m1_final:
    s_lshl_b32 s86, s0, 6
    buffer_store_short v48, v20, s[48:51], s86 offen
m1_done:
    s_endpgm
m1_O0_rt:
    s_sub_u32 s60, s60, 1
    s_nop 7
    s_cbranch_scc0 m1_O0_try
    s_mov_b32 s60, 0
    s_branch m1_O0_ok
m1_P_rt:
    s_sub_u32 s60, s60, 1
    s_nop 7
    s_cbranch_scc0 m1_P_try
    s_mov_b32 s60, 0
    s_branch m1_P_ok
m1_Q_rt:
    s_sub_u32 s60, s60, 1
    s_nop 7
    s_cbranch_scc0 m1_Q_try
    s_mov_b32 s60, 0
    s_branch m1_Q_ok
m1_ML_rt:
    s_sub_u32 s60, s60, 1
    s_nop 7
    s_cbranch_scc0 m1_ML_try
    s_mov_b32 s60, 0
    s_branch m1_ML_ok
m1_O_rt:
    s_sub_u32 s60, s60, 1
    s_nop 7
    s_cbranch_scc0 m1_O_try
    s_mov_b32 s60, 0
    s_branch m1_O_ok
m1_E_rt:
    s_sub_u32 s60, s60, 1
    s_nop 7
    s_cbranch_scc0 m1_E_try
    s_mov_b32 s60, 0
    s_branch m1_E_ok
m1_S_rt:
    s_sub_u32 s60, s60, 1
    s_nop 7
    s_cbranch_scc0 m1_S_try
    s_mov_b32 s60, 0
    s_branch m1_S_ok
m1_R_rt:
    s_sub_u32 s60, s60, 1
    s_nop 7
    s_cbranch_scc0 m1_R_try
    s_mov_b32 s60, 0
    s_branch m1_R_ok
m1_UV_rt:
    s_sub_u32 s60, s60, 1
    s_nop 7
    s_cbranch_scc0 m1_UV_try
    s_mov_b32 s60, 0
    s_branch m1_UV_ok
m1_O0_try:
    s_mov_b32 exec_lo, 0x00ff00ff
    s_mov_b32 exec_hi, 0x00ff00ff
    buffer_load_dwordx4 v[24:27], v48, s[56:59], s66 offen offset:0 sc1
    buffer_load_dwordx4 v[28:31], v48, s[56:59], s66 offen offset:512 sc1
    buffer_load_dwordx4 v[32:35], v48, s[56:59], s66 offen offset:1024 sc1
    buffer_load_dwordx4 v[36:39], v48, s[56:59], s66 offen offset:1536 sc1
    s_mov_b64 exec, -1
    s_waitcnt vmcnt(0)
    s_branch m1_O0_go
m1_P_try:
    s_mov_b64 exec, 0x3ff
    buffer_load_dwordx4 v[40:43], v2, s[56:59], s72 offen sc1
    s_mov_b64 exec, s[88:89]
    buffer_load_dwordx4 v[24:27], v16, s[56:59], s70 offen offset:0 sc1
    buffer_load_dwordx4 v[28:31], v16, s[56:59], s70 offen offset:64 sc1
    buffer_load_dwordx4 v[32:35], v16, s[56:59], s70 offen offset:128 sc1
    buffer_load_dwordx4 v[36:39], v16, s[56:59], s70 offen offset:192 sc1
    s_mov_b64 exec, -1
    s_branch m1_P_go
m1_P_rq:
    s_sub_u32 s60, s60, 1
    s_cbranch_scc0 m1_P_try
    s_mov_b32 s60, 0
    s_branch m1_P_rqo
m1_ML_try:
    buffer_load_dwordx4 v[36:39], v13, s[56:59], s64 offen sc1
    s_waitcnt vmcnt(0)
    v_max_f32 v40, v36, v38
    s_nop 1
    v_max_f32_dpp v40, v40, v40 row_ror:8 row_mask:0xf bank_mask:0xf
    s_nop 1
    v_max_f32_dpp v40, v40, v40 row_ror:4 row_mask:0xf bank_mask:0xf
    s_nop 1
    v_max_f32_dpp v40, v40, v40 row_ror:2 row_mask:0xf bank_mask:0xf
    s_nop 1
    v_max_f32_dpp v40, v40, v40 row_ror:1 row_mask:0xf bank_mask:0xf
    v_sub_f32 v41, v36, v40
    v_sub_f32 v42, v38, v40
    v_exp_f32 v41, v41
    v_exp_f32 v42, v42
    v_mul_f32 v43, v41, v37
    v_fmac_f32 v43, v42, v39
    s_nop 1
    v_add_f32_dpp v43, v43, v43 row_ror:8 row_mask:0xf bank_mask:0xf
    s_nop 1
    v_add_f32_dpp v43, v43, v43 row_ror:4 row_mask:0xf bank_mask:0xf
    s_nop 1
    v_add_f32_dpp v43, v43, v43 row_ror:2 row_mask:0xf bank_mask:0xf
    s_nop 1
    v_add_f32_dpp v43, v43, v43 row_ror:1 row_mask:0xf bank_mask:0xf
    v_cmp_u_f32 vcc, v43, v43
    v_rcp_f32 v43, v43
    s_nop 0
    v_mul_f32 v41, v41, v43
    v_mul_f32 v42, v42, v43
    s_cbranch_vccnz m1_ML_rt
    s_nop 0
    s_branch m1_ML_ok
m1_R_try:
    ds_read_b64_tr_b16 v[56:57], v10 offset:0
    ds_read_b64_tr_b16 v[58:59], v10 offset:384
    ds_read_b64_tr_b16 v[60:61], v10 offset:32
    ds_read_b64_tr_b16 v[62:63], v10 offset:416
    ds_read_b64_tr_b16 v[64:65], v10 offset:64
    ds_read_b64_tr_b16 v[66:67], v10 offset:448
    ds_read_b64_tr_b16 v[68:69], v10 offset:768
    ds_read_b64_tr_b16 v[70:71], v10 offset:1152
    s_branch m1_R_go
m1_UV_try:
    buffer_load_dwordx4 v[48:51], v52, s[56:59], s80 offen sc1
    s_branch m1_UV_w
L_exit:
    s_endpgm
.section .rodata,"a"
.p2align 6
.amdhsa_kernel interleave_layers__gqa_block_cached__compressed_kv_cla__decode_kernel
  .amdhsa_next_free_vgpr 512
  .amdhsa_next_free_sgpr 102
  .amdhsa_accum_offset 256
  .amdhsa_group_segment_fixed_size 0
  .amdhsa_kernarg_size 112
  .amdhsa_user_sgpr_count 2
  .amdhsa_user_sgpr_kernarg_segment_ptr 1
  .amdhsa_system_sgpr_workgroup_id_x 1
.end_amdhsa_kernel
```
